```python
import torch

def _softmax(x, axis=-1):
    return torch.softmax(x, dim=axis)

def _gelu(x):
    return torch.nn.functional.gelu(x, approximate='tanh')

def _silu(x):
    return torch.nn.functional.silu(x)

def _sigmoid(x):
    return torch.sigmoid(x)

def _layernorm(x, axis=-1, eps=1e-05):
    m = x.mean(dim=axis, keepdim=True)
    v = x.var(dim=axis, keepdim=True, unbiased=False)
    return (x - m) / torch.sqrt(v + eps)

def _scatter_add(tgt, idx, src, axis=0):
    return tgt.clone().index_add_(axis, idx, src)

def _segment_sum(src, seg, n):
    out = torch.zeros((n,) + src.shape[1:], dtype=src.dtype)
    return out.index_add_(0, seg, src)

def _pad(x, pw):
    flat = tuple((v for pair in reversed(pw) for v in pair))
    return torch.nn.functional.pad(x, flat)
kernel_name = 'adaLN_cond__gqa_block_cached__glu_gated_bilinear__decode'

def setup_inputs():

    _w = lambda a: (lambda t: t.to(torch.bfloat16) if t.is_floating_point() else t)(torch.as_tensor(a))

    def _A_setup():
        B, Sq, D = (4, 1, 512)
        Hq, Hkv, Sk, Dh = (32, 8, 8192, 128)
        assert Hq % Hkv == 0, (Hq, Hkv)
        return {'x': _w((lambda *s: torch.randn(*s, dtype=torch.bfloat16) * 0.1)(B, Sq, D)), 'k_cache': _w((lambda *s: torch.randn(*s, dtype=torch.bfloat16) * 0.8)(B, Hkv, Sk, Dh)), 'v_cache': _w((lambda *s: torch.randn(*s, dtype=torch.bfloat16) * 3.2)(B, Hkv, Sk, Dh)), 'wq': _w((lambda *s: torch.randn(*s, dtype=torch.bfloat16) * 0.8)(D, Hq * Dh) * D ** (-0.5)), 'wo': _w((lambda *s: torch.randn(*s, dtype=torch.bfloat16) * 3.2)(Hq * Dh, D) * (Hq * Dh) ** (-0.5))}
    _A_in = _A_setup()

    def _B_setup():
        B, S, D, F = (4, 1, 512, 1792)
        return {'x': _w((lambda *s: torch.randn(*s, dtype=torch.bfloat16) * 0.1)(B, S, D)), 'w_gate': _w((lambda *s: torch.randn(*s, dtype=torch.bfloat16) * 3.2)(D, F) * D ** (-0.5)), 'w_up': _w((lambda *s: torch.randn(*s, dtype=torch.bfloat16) * 3.2)(D, F) * D ** (-0.5)), 'w_down': _w((lambda *s: torch.randn(*s, dtype=torch.bfloat16) * 3.2)(F, D) * F ** (-0.5))}
    _B_in = _B_setup()
    return {'A_x': _A_in['x'], 'A_k_cache': _A_in['k_cache'], 'A_v_cache': _A_in['v_cache'], 'A_wq': _A_in['wq'], 'A_wo': _A_in['wo'], 'B_x': _B_in['x'], 'B_w_gate': _B_in['w_gate'], 'B_w_up': _B_in['w_up'], 'B_w_down': _B_in['w_down'], 'c': _w((lambda *s: torch.randn(*s, dtype=torch.bfloat16) * 0.4)(4, 512) * 8.0), 'w_mod': _w((lambda *s: torch.randn(*s, dtype=torch.bfloat16) * 0.4)(512, 6 * 512) * 512 ** (-0.5) * 8.0)}

def reference(A_x, A_k_cache, A_v_cache, A_wq, A_wo, B_x, B_w_gate, B_w_up, B_w_down, c, w_mod):

    def _A_ref(x, k_cache, v_cache, wq, wo):
        B, Sq, D = x.shape
        Hq, Dh = (32, 128)
        Hkv = k_cache.shape[1]
        rep = Hq // Hkv
        q = (lambda x, *d: x.permute(*d))((x @ wq).reshape(B, Sq, Hq, Dh), 0, 2, 1, 3)
        k = (lambda x, n, axis: torch.repeat_interleave(x, n, dim=axis))(k_cache, rep, axis=1)
        v = (lambda x, n, axis: torch.repeat_interleave(x, n, dim=axis))(v_cache, rep, axis=1)
        scores = torch.einsum('bhqd,bhkd->bhqk', q, k) * Dh ** (-0.5)
        p = _softmax(scores, axis=-1)
        o = torch.einsum('bhqk,bhkd->bhqd', p, v)
        return (lambda x, *d: x.permute(*d))(o, 0, 2, 1, 3).reshape(B, Sq, Hq * Dh) @ wo

    def _B_ref(x, w_gate, w_up, w_down):
        g = torch.einsum('bsd,df->bsf', x, w_gate)
        u = torch.einsum('bsd,df->bsf', x, w_up)
        h = g * u
        return torch.einsum('bsf,fd->bsd', h, w_down)
    x = A_x
    mod = (_silu(c) @ w_mod).reshape(c.shape[0], 6, 1, -1)
    sa, ca, ga, sb, cb, gb = (mod[:, 0].clone(), mod[:, 1].clone(), mod[:, 2].clone(), mod[:, 3].clone(), mod[:, 4].clone(), mod[:, 5].clone())
    h = _layernorm(x, axis=-1) * (1 + ca) + sa
    x = x + ga * _A_ref(h, A_k_cache, A_v_cache, A_wq, A_wo)
    h = _layernorm(x, axis=-1) * (1 + cb) + sb
    x = x + gb * _B_ref(h, B_w_gate, B_w_up, B_w_down)
    return x
```

```asm
; @launch grid=(256,1,1) block=(512,1,1) lds=163840
.amdgcn_target "amdgcn-amd-amdhsa--gfx950"
.text
.globl adaLN_cond__gqa_block_cached__glu_gated_bilinear__decode_kernel
.p2align 8
.type adaLN_cond__gqa_block_cached__glu_gated_bilinear__decode_kernel,@function
adaLN_cond__gqa_block_cached__glu_gated_bilinear__decode_kernel:
    s_cmp_ge_u32 s2, 256
    s_cbranch_scc1 L_exit
    s_load_dwordx16 s[16:31], s[0:1], 0
    s_load_dwordx8 s[32:39], s[0:1], 64
    s_load_dwordx4 s[40:43], s[0:1], 96
    v_lshrrev_b32 v1, 6, v0
    v_and_b32 v0, 63, v0
    v_readfirstlane_b32 s7, v1
    s_mov_b32 s3, s2
    s_lshr_b32 s4, s2, 6
    s_lshr_b32 s6, s2, 3
    s_sub_u32 s6, s2, s6
    s_and_b32 s6, s6, 7
    s_bfe_u32 s5, s2, 0x30003
    s_lshl_b32 s95, s4, 3
    s_add_u32 s95, s95, s5
    s_lshl_b32 s2, s95, 3
    s_add_u32 s2, s2, s6
    s_mov_b32 s14, 0xffff0000
    s_mov_b32 s15, 0x3fb8aa3b
    s_mov_b32 s92, 0x05040100
    s_mov_b32 s93, 0x07060302
    v_and_b32 v2, 15, v0
    v_lshrrev_b32 v3, 4, v0
    s_cmp_ge_u32 s7, 4
    s_cbranch_scc1 L_service
    v_and_b32 v4, 3, v2
    v_lshlrev_b32 v4, 10, v4
    v_lshrrev_b32 v5, 2, v2
    v_lshlrev_b32 v5, 8, v5
    v_add_u32 v4, v4, v5
    v_lshlrev_b32 v5, 4, v3
    v_add_u32 v4, v4, v5
    v_lshlrev_b32 v5, 4, v0
    s_lshl_b32 s8, s2, 18
    s_lshl_b32 s9, s7, 13
    s_add_u32 s8, s8, s9
    s_waitcnt lgkmcnt(0)
    s_barrier
    s_add_u32 s44, s18, s8
    s_addc_u32 s45, s19, 0
    s_mov_b32 s46, 237568
    s_mov_b32 s47, 0x20000
    s_add_u32 s48, s20, s8
    s_addc_u32 s49, s21, 0
    s_mov_b32 s50, 237568
    s_mov_b32 s51, 0x20000
    s_lshl_b32 s11, s7, 15
    s_add_u32 s11, s11, 32768
    s_mov_b32 s52, s42
    s_mov_b32 s53, s43
    s_mov_b32 s54, 2097152
    s_mov_b32 s55, 0x20000
    s_mov_b32 s10, 0
    buffer_load_dwordx4 v[64:67], v4, s[44:47], s10 offen offset:0
    buffer_load_dwordx4 v[68:71], v4, s[44:47], s10 offen offset:64
    buffer_load_dwordx4 v[72:75], v4, s[44:47], s10 offen offset:128
    buffer_load_dwordx4 v[76:79], v4, s[44:47], s10 offen offset:192
    s_mov_b32 s10, 4096
    buffer_load_dwordx4 v[80:83], v4, s[44:47], s10 offen offset:0
    buffer_load_dwordx4 v[84:87], v4, s[44:47], s10 offen offset:64
    buffer_load_dwordx4 v[88:91], v4, s[44:47], s10 offen offset:128
    buffer_load_dwordx4 v[92:95], v4, s[44:47], s10 offen offset:192
    s_mov_b32 s94, 0x3db504f3
    s_mov_b32 s84, 0xf000f
    s_mov_b32 s85, 0xf000f
    s_mov_b32 s86, 0xf000f0
    s_mov_b32 s87, 0xf000f0
    s_mov_b32 s88, 0xf000f00
    s_mov_b32 s89, 0xf000f00
    s_mov_b32 s90, 0xf000f000
    s_mov_b32 s91, 0xf000f000
    v_and_b32 v57, 3, v2
    v_lshlrev_b32 v57, 8, v57
    v_lshlrev_b32 v58, 4, v3
    v_add_u32 v57, v57, v58
    v_mov_b32 v7, 0
    v_add_u32 v63, s11, v5
    s_mov_b32 s10, 0
    buffer_load_dwordx4 v[96:99], v5, s[48:51], s10 offen offset:0 nt
    buffer_load_dwordx4 v[100:103], v5, s[48:51], s10 offen offset:1024 nt
    buffer_load_dwordx4 v[104:107], v5, s[48:51], s10 offen offset:2048 nt
    buffer_load_dwordx4 v[108:111], v5, s[48:51], s10 offen offset:3072 nt
    s_mov_b32 s10, 4096
    buffer_load_dwordx4 v[112:115], v5, s[48:51], s10 offen offset:0 nt
    buffer_load_dwordx4 v[116:119], v5, s[48:51], s10 offen offset:1024 nt
    buffer_load_dwordx4 v[120:123], v5, s[48:51], s10 offen offset:2048 nt
    buffer_load_dwordx4 v[124:127], v5, s[48:51], s10 offen offset:3072 nt
    s_mov_b32 s10, 32768
    buffer_load_dwordx4 v[128:131], v4, s[44:47], s10 offen offset:0
    buffer_load_dwordx4 v[132:135], v4, s[44:47], s10 offen offset:64
    buffer_load_dwordx4 v[136:139], v4, s[44:47], s10 offen offset:128
    buffer_load_dwordx4 v[140:143], v4, s[44:47], s10 offen offset:192
    s_mov_b32 s10, 36864
    buffer_load_dwordx4 v[144:147], v4, s[44:47], s10 offen offset:0
    buffer_load_dwordx4 v[148:151], v4, s[44:47], s10 offen offset:64
    buffer_load_dwordx4 v[152:155], v4, s[44:47], s10 offen offset:128
    buffer_load_dwordx4 v[156:159], v4, s[44:47], s10 offen offset:192
    s_mov_b32 s10, 32768
    buffer_load_dwordx4 v[160:163], v5, s[48:51], s10 offen offset:0 nt
    buffer_load_dwordx4 v[164:167], v5, s[48:51], s10 offen offset:1024 nt
    buffer_load_dwordx4 v[168:171], v5, s[48:51], s10 offen offset:2048 nt
    buffer_load_dwordx4 v[172:175], v5, s[48:51], s10 offen offset:3072 nt
    s_mov_b32 s10, 36864
    buffer_load_dwordx4 v[176:179], v5, s[48:51], s10 offen offset:0 nt
    buffer_load_dwordx4 v[180:183], v5, s[48:51], s10 offen offset:1024 nt
    buffer_load_dwordx4 v[184:187], v5, s[48:51], s10 offen offset:2048 nt
    buffer_load_dwordx4 v[188:191], v5, s[48:51], s10 offen offset:3072 nt
    s_mov_b32 s10, 65536
    buffer_load_dwordx4 v[192:195], v4, s[44:47], s10 offen offset:0
    buffer_load_dwordx4 v[196:199], v4, s[44:47], s10 offen offset:64
    buffer_load_dwordx4 v[200:203], v4, s[44:47], s10 offen offset:128
    buffer_load_dwordx4 v[204:207], v4, s[44:47], s10 offen offset:192
    s_mov_b32 s10, 69632
    buffer_load_dwordx4 v[208:211], v4, s[44:47], s10 offen offset:0
    buffer_load_dwordx4 v[212:215], v4, s[44:47], s10 offen offset:64
    buffer_load_dwordx4 v[216:219], v4, s[44:47], s10 offen offset:128
    buffer_load_dwordx4 v[220:223], v4, s[44:47], s10 offen offset:192
    s_waitcnt vmcnt(39)
    s_mov_b32 s10, 65536
    buffer_load_dwordx4 v[224:227], v5, s[48:51], s10 offen offset:0 nt
    s_waitcnt vmcnt(39)
    buffer_load_dwordx4 v[228:231], v5, s[48:51], s10 offen offset:1024 nt
    s_waitcnt vmcnt(39)
    buffer_load_dwordx4 v[232:235], v5, s[48:51], s10 offen offset:2048 nt
    s_waitcnt vmcnt(39)
    buffer_load_dwordx4 v[236:239], v5, s[48:51], s10 offen offset:3072 nt
    s_waitcnt vmcnt(39)
    s_mov_b32 s10, 69632
    buffer_load_dwordx4 v[240:243], v5, s[48:51], s10 offen offset:0 nt
    s_waitcnt vmcnt(39)
    buffer_load_dwordx4 v[244:247], v5, s[48:51], s10 offen offset:1024 nt
    s_waitcnt vmcnt(39)
    buffer_load_dwordx4 v[248:251], v5, s[48:51], s10 offen offset:2048 nt
    s_waitcnt vmcnt(39)
    buffer_load_dwordx4 v[252:255], v5, s[48:51], s10 offen offset:3072 nt
    s_waitcnt vmcnt(39)
    s_add_u32 m0, s11, 0
    s_mov_b32 s10, 98304
    buffer_load_dwordx4 v4, s[44:47], s10 offen offset:0  lds
    s_waitcnt vmcnt(39)
    s_add_u32 m0, s11, 960
    s_nop 0
    buffer_load_dwordx4 v4, s[44:47], s10 offen offset:64  lds
    s_waitcnt vmcnt(39)
    s_add_u32 m0, s11, 1920
    s_nop 0
    buffer_load_dwordx4 v4, s[44:47], s10 offen offset:128  lds
    s_waitcnt vmcnt(39)
    s_add_u32 m0, s11, 2880
    s_nop 0
    buffer_load_dwordx4 v4, s[44:47], s10 offen offset:192  lds
    s_waitcnt vmcnt(39)
    s_add_u32 m0, s11, 4096
    s_mov_b32 s10, 102400
    buffer_load_dwordx4 v4, s[44:47], s10 offen offset:0  lds
    s_waitcnt vmcnt(39)
    s_add_u32 m0, s11, 5056
    s_nop 0
    buffer_load_dwordx4 v4, s[44:47], s10 offen offset:64  lds
    s_waitcnt vmcnt(39)
    s_add_u32 m0, s11, 6016
    s_nop 0
    buffer_load_dwordx4 v4, s[44:47], s10 offen offset:128  lds
    s_waitcnt vmcnt(39)
    s_add_u32 m0, s11, 6976
    s_nop 0
    buffer_load_dwordx4 v4, s[44:47], s10 offen offset:192  lds
    s_waitcnt vmcnt(39)
    s_add_u32 m0, s11, 8192
    s_mov_b32 s10, 98304
    buffer_load_dwordx4 v5, s[48:51], s10 offen offset:0 nt lds
    s_waitcnt vmcnt(39)
    s_add_u32 m0, s11, 8192
    s_nop 0
    buffer_load_dwordx4 v5, s[48:51], s10 offen offset:1024 nt lds
    s_waitcnt vmcnt(39)
    s_add_u32 m0, s11, 8192
    s_nop 0
    buffer_load_dwordx4 v5, s[48:51], s10 offen offset:2048 nt lds
    s_waitcnt vmcnt(39)
    s_add_u32 m0, s11, 8192
    s_nop 0
    buffer_load_dwordx4 v5, s[48:51], s10 offen offset:3072 nt lds
    s_waitcnt vmcnt(39)
    s_add_u32 m0, s11, 12288
    s_mov_b32 s10, 102400
    buffer_load_dwordx4 v5, s[48:51], s10 offen offset:0 nt lds
    s_waitcnt vmcnt(39)
    s_add_u32 m0, s11, 12288
    s_nop 0
    buffer_load_dwordx4 v5, s[48:51], s10 offen offset:1024 nt lds
    s_waitcnt vmcnt(39)
    s_add_u32 m0, s11, 12288
    s_nop 0
    buffer_load_dwordx4 v5, s[48:51], s10 offen offset:2048 nt lds
    s_waitcnt vmcnt(39)
    s_add_u32 m0, s11, 12288
    s_nop 0
    buffer_load_dwordx4 v5, s[48:51], s10 offen offset:3072 nt lds
    s_waitcnt vmcnt(39)
    s_add_u32 m0, s11, 16384
    s_mov_b32 s10, 131072
    buffer_load_dwordx4 v4, s[44:47], s10 offen offset:0  lds
    s_waitcnt vmcnt(39)
    s_add_u32 m0, s11, 17344
    s_nop 0
    buffer_load_dwordx4 v4, s[44:47], s10 offen offset:64  lds
    s_waitcnt vmcnt(39)
    s_add_u32 m0, s11, 18304
    s_nop 0
    buffer_load_dwordx4 v4, s[44:47], s10 offen offset:128  lds
    s_waitcnt vmcnt(39)
    s_add_u32 m0, s11, 19264
    s_nop 0
    buffer_load_dwordx4 v4, s[44:47], s10 offen offset:192  lds
    s_waitcnt vmcnt(39)
    s_add_u32 m0, s11, 20480
    s_mov_b32 s10, 135168
    buffer_load_dwordx4 v4, s[44:47], s10 offen offset:0  lds
    s_waitcnt vmcnt(39)
    s_add_u32 m0, s11, 21440
    s_nop 0
    buffer_load_dwordx4 v4, s[44:47], s10 offen offset:64  lds
    s_waitcnt vmcnt(39)
    s_add_u32 m0, s11, 22400
    s_nop 0
    buffer_load_dwordx4 v4, s[44:47], s10 offen offset:128  lds
    s_waitcnt vmcnt(39)
    s_add_u32 m0, s11, 23360
    s_nop 0
    buffer_load_dwordx4 v4, s[44:47], s10 offen offset:192  lds
    s_waitcnt vmcnt(39)
    s_add_u32 m0, s11, 24576
    s_mov_b32 s10, 131072
    buffer_load_dwordx4 v5, s[48:51], s10 offen offset:0 nt lds
    s_waitcnt vmcnt(39)
    s_add_u32 m0, s11, 24576
    s_nop 0
    buffer_load_dwordx4 v5, s[48:51], s10 offen offset:1024 nt lds
    s_waitcnt vmcnt(39)
    s_add_u32 m0, s11, 24576
    s_nop 0
    buffer_load_dwordx4 v5, s[48:51], s10 offen offset:2048 nt lds
    s_waitcnt vmcnt(39)
    s_add_u32 m0, s11, 24576
    s_nop 0
    buffer_load_dwordx4 v5, s[48:51], s10 offen offset:3072 nt lds
    s_waitcnt vmcnt(39)
    s_add_u32 m0, s11, 28672
    s_mov_b32 s10, 135168
    buffer_load_dwordx4 v5, s[48:51], s10 offen offset:0 nt lds
    s_waitcnt vmcnt(39)
    s_add_u32 m0, s11, 28672
    s_nop 0
    buffer_load_dwordx4 v5, s[48:51], s10 offen offset:1024 nt lds
    s_waitcnt vmcnt(39)
    s_add_u32 m0, s11, 28672
    s_nop 0
    buffer_load_dwordx4 v5, s[48:51], s10 offen offset:2048 nt lds
    s_waitcnt vmcnt(39)
    s_add_u32 m0, s11, 28672
    s_nop 0
    buffer_load_dwordx4 v5, s[48:51], s10 offen offset:3072 nt lds
    v_mov_b32 v58, 0
    s_mov_b32 s13, 100000
L_qw:
    ds_read_b128 v[8:11], v58 offset:32
    s_waitcnt lgkmcnt(0)
    v_and_b32 v8, v8, v9
    v_and_b32 v10, v10, v11
    v_and_b32 v8, v8, v10
    v_cmp_eq_u32 vcc, 0, v8
    s_cbranch_vccz L_qw_done
    s_sleep 2
    s_sub_u32 s13, s13, 1
    s_cbranch_scc0 L_qw
L_qw_done:
    ds_read_b128 v[8:11], v57 offset:256
    ds_read_b128 v[12:15], v57 offset:320
    ds_read_b128 v[16:19], v57 offset:384
    ds_read_b128 v[20:23], v57 offset:448
    s_waitcnt lgkmcnt(0)
    v_mfma_f32_16x16x32_bf16 v[32:35], v[64:67], v[8:11], 0
    v_mfma_f32_16x16x32_bf16 v[36:39], v[80:83], v[8:11], 0
    v_mfma_f32_16x16x32_bf16 v[32:35], v[68:71], v[12:15], v[32:35]
    v_mfma_f32_16x16x32_bf16 v[36:39], v[84:87], v[12:15], v[36:39]
    v_mfma_f32_16x16x32_bf16 v[32:35], v[72:75], v[16:19], v[32:35]
    v_mfma_f32_16x16x32_bf16 v[36:39], v[88:91], v[16:19], v[36:39]
    v_mfma_f32_16x16x32_bf16 v[32:35], v[76:79], v[20:23], v[32:35]
    v_mfma_f32_16x16x32_bf16 v[36:39], v[92:95], v[20:23], v[36:39]
    s_nop 7
    v_cvt_pk_bf16_f32 v57, v32, v33
    v_cvt_pk_bf16_f32 v58, v34, v35
    v_cvt_pk_bf16_f32 v59, v36, v37
    v_cvt_pk_bf16_f32 v60, v38, v39
    v_lshlrev_b32 v32, 16, v57
    v_and_b32 v33, s14, v57
    v_lshlrev_b32 v34, 16, v58
    v_and_b32 v35, s14, v58
    v_lshlrev_b32 v36, 16, v59
    v_and_b32 v37, s14, v59
    v_lshlrev_b32 v38, 16, v60
    v_and_b32 v39, s14, v60
    v_mul_f32 v32, s94, v32
    v_mul_f32 v33, s94, v33
    v_mul_f32 v34, s94, v34
    v_mul_f32 v35, s94, v35
    v_mul_f32 v36, s94, v36
    v_mul_f32 v37, s94, v37
    v_mul_f32 v38, s94, v38
    v_mul_f32 v39, s94, v39
    v_cvt_pk_bf16_f32 v57, v32, v33
    v_cvt_pk_bf16_f32 v58, v34, v35
    v_cvt_pk_bf16_f32 v59, v36, v37
    v_cvt_pk_bf16_f32 v60, v38, v39
    v_lshlrev_b32 v32, 16, v57
    v_and_b32 v33, s14, v57
    v_lshlrev_b32 v34, 16, v58
    v_and_b32 v35, s14, v58
    v_lshlrev_b32 v36, 16, v59
    v_and_b32 v37, s14, v59
    v_lshlrev_b32 v38, 16, v60
    v_and_b32 v39, s14, v60
    v_max3_f32 v61, v32, v33, v34
    v_max3_f32 v62, v35, v36, v37
    v_max3_f32 v61, v61, v38, v39
    v_max_f32 v61, v61, v62
    v_mov_b32 v62, v61
    s_nop 1
    v_permlane16_swap_b32 v61, v62
    v_max_f32 v61, v61, v62
    v_mov_b32 v62, v61
    s_nop 1
    v_permlane32_swap_b32 v61, v62
    v_max_f32 v61, v61, v62
    v_mov_b32 v6, v61
    v_mul_f32 v62, s15, v61
    v_fma_f32 v32, v32, s15, -v62
    v_fma_f32 v33, v33, s15, -v62
    v_fma_f32 v34, v34, s15, -v62
    v_fma_f32 v35, v35, s15, -v62
    v_fma_f32 v36, v36, s15, -v62
    v_fma_f32 v37, v37, s15, -v62
    v_fma_f32 v38, v38, s15, -v62
    v_fma_f32 v39, v39, s15, -v62
    v_exp_f32 v32, v32
    v_exp_f32 v33, v33
    v_exp_f32 v34, v34
    v_exp_f32 v35, v35
    v_exp_f32 v36, v36
    v_exp_f32 v37, v37
    v_exp_f32 v38, v38
    v_exp_f32 v39, v39
    s_nop 0
    v_cvt_pk_bf16_f32 v57, v32, v33
    v_cvt_pk_bf16_f32 v58, v34, v35
    v_cvt_pk_bf16_f32 v59, v36, v37
    v_cvt_pk_bf16_f32 v60, v38, v39
    v_add_f32 v61, v32, v33
    v_add_f32 v62, v34, v35
    v_add_f32 v32, v36, v37
    v_add_f32 v33, v38, v39
    v_add_f32 v61, v61, v62
    v_add_f32 v32, v32, v33
    v_add_f32 v61, v61, v32
    v_add_f32 v7, v7, v61
    v_cndmask_b32_e64 v40, 0, v57, s[84:85]
    v_cndmask_b32_e64 v41, 0, v58, s[84:85]
    v_cndmask_b32_e64 v42, 0, v59, s[84:85]
    v_cndmask_b32_e64 v43, 0, v60, s[84:85]
    v_cndmask_b32_e64 v44, 0, v57, s[86:87]
    v_cndmask_b32_e64 v45, 0, v58, s[86:87]
    v_cndmask_b32_e64 v46, 0, v59, s[86:87]
    v_cndmask_b32_e64 v47, 0, v60, s[86:87]
    v_cndmask_b32_e64 v48, 0, v57, s[88:89]
    v_cndmask_b32_e64 v49, 0, v58, s[88:89]
    v_cndmask_b32_e64 v50, 0, v59, s[88:89]
    v_cndmask_b32_e64 v51, 0, v60, s[88:89]
    v_cndmask_b32_e64 v52, 0, v57, s[90:91]
    v_cndmask_b32_e64 v53, 0, v58, s[90:91]
    v_cndmask_b32_e64 v54, 0, v59, s[90:91]
    v_cndmask_b32_e64 v55, 0, v60, s[90:91]
    v_perm_b32 v64, v100, v96, s92
    v_perm_b32 v65, v108, v104, s92
    v_perm_b32 v66, v116, v112, s92
    v_perm_b32 v67, v124, v120, s92
    v_perm_b32 v68, v100, v96, s93
    v_perm_b32 v69, v108, v104, s93
    v_perm_b32 v70, v116, v112, s93
    v_perm_b32 v71, v124, v120, s93
    v_perm_b32 v72, v101, v97, s92
    v_perm_b32 v73, v109, v105, s92
    v_perm_b32 v74, v117, v113, s92
    v_perm_b32 v75, v125, v121, s92
    v_perm_b32 v76, v101, v97, s93
    v_perm_b32 v77, v109, v105, s93
    v_perm_b32 v78, v117, v113, s93
    v_perm_b32 v79, v125, v121, s93
    v_perm_b32 v80, v102, v98, s92
    v_perm_b32 v81, v110, v106, s92
    v_perm_b32 v82, v118, v114, s92
    v_perm_b32 v83, v126, v122, s92
    v_perm_b32 v84, v102, v98, s93
    v_perm_b32 v85, v110, v106, s93
    v_perm_b32 v86, v118, v114, s93
    v_perm_b32 v87, v126, v122, s93
    v_perm_b32 v88, v103, v99, s92
    v_perm_b32 v89, v111, v107, s92
    v_perm_b32 v90, v119, v115, s92
    v_perm_b32 v91, v127, v123, s92
    v_perm_b32 v92, v103, v99, s93
    v_perm_b32 v93, v111, v107, s93
    v_perm_b32 v94, v119, v115, s93
    v_perm_b32 v95, v127, v123, s93
    s_mov_b32 s10, 163840
    buffer_load_dwordx4 v[96:99], v4, s[44:47], s10 offen offset:0
    buffer_load_dwordx4 v[100:103], v4, s[44:47], s10 offen offset:64
    buffer_load_dwordx4 v[104:107], v4, s[44:47], s10 offen offset:128
    buffer_load_dwordx4 v[108:111], v4, s[44:47], s10 offen offset:192
    s_mov_b32 s10, 167936
    buffer_load_dwordx4 v[112:115], v4, s[44:47], s10 offen offset:0
    buffer_load_dwordx4 v[116:119], v4, s[44:47], s10 offen offset:64
    buffer_load_dwordx4 v[120:123], v4, s[44:47], s10 offen offset:128
    buffer_load_dwordx4 v[124:127], v4, s[44:47], s10 offen offset:192
    v_mfma_f32_16x16x32_bf16 v[24:27], v[40:43], v[64:67], 0
    v_mfma_f32_16x16x32_bf16 v[28:31], v[40:43], v[80:83], 0
    v_mfma_f32_16x16x32_bf16 v[24:27], v[44:47], v[68:71], v[24:27]
    v_mfma_f32_16x16x32_bf16 v[28:31], v[44:47], v[84:87], v[28:31]
    v_mfma_f32_16x16x32_bf16 v[24:27], v[48:51], v[72:75], v[24:27]
    v_mfma_f32_16x16x32_bf16 v[28:31], v[48:51], v[88:91], v[28:31]
    v_mfma_f32_16x16x32_bf16 v[24:27], v[52:55], v[76:79], v[24:27]
    v_mfma_f32_16x16x32_bf16 v[28:31], v[52:55], v[92:95], v[28:31]
    s_mov_b32 s10, 163840
    buffer_load_dwordx4 v[64:67], v5, s[48:51], s10 offen offset:0 nt
    buffer_load_dwordx4 v[68:71], v5, s[48:51], s10 offen offset:1024 nt
    buffer_load_dwordx4 v[72:75], v5, s[48:51], s10 offen offset:2048 nt
    buffer_load_dwordx4 v[76:79], v5, s[48:51], s10 offen offset:3072 nt
    s_mov_b32 s10, 167936
    buffer_load_dwordx4 v[80:83], v5, s[48:51], s10 offen offset:0 nt
    buffer_load_dwordx4 v[84:87], v5, s[48:51], s10 offen offset:1024 nt
    buffer_load_dwordx4 v[88:91], v5, s[48:51], s10 offen offset:2048 nt
    buffer_load_dwordx4 v[92:95], v5, s[48:51], s10 offen offset:3072 nt
    v_mfma_f32_16x16x32_bf16 v[32:35], v[128:131], v[8:11], 0
    v_mfma_f32_16x16x32_bf16 v[36:39], v[144:147], v[8:11], 0
    v_mfma_f32_16x16x32_bf16 v[32:35], v[132:135], v[12:15], v[32:35]
    v_mfma_f32_16x16x32_bf16 v[36:39], v[148:151], v[12:15], v[36:39]
    v_mfma_f32_16x16x32_bf16 v[32:35], v[136:139], v[16:19], v[32:35]
    v_mfma_f32_16x16x32_bf16 v[36:39], v[152:155], v[16:19], v[36:39]
    v_mfma_f32_16x16x32_bf16 v[32:35], v[140:143], v[20:23], v[32:35]
    v_mfma_f32_16x16x32_bf16 v[36:39], v[156:159], v[20:23], v[36:39]
    s_nop 7
    v_cvt_pk_bf16_f32 v57, v32, v33
    v_cvt_pk_bf16_f32 v58, v34, v35
    v_cvt_pk_bf16_f32 v59, v36, v37
    v_cvt_pk_bf16_f32 v60, v38, v39
    v_lshlrev_b32 v32, 16, v57
    v_and_b32 v33, s14, v57
    v_lshlrev_b32 v34, 16, v58
    v_and_b32 v35, s14, v58
    v_lshlrev_b32 v36, 16, v59
    v_and_b32 v37, s14, v59
    v_lshlrev_b32 v38, 16, v60
    v_and_b32 v39, s14, v60
    v_mul_f32 v32, s94, v32
    v_mul_f32 v33, s94, v33
    v_mul_f32 v34, s94, v34
    v_mul_f32 v35, s94, v35
    v_mul_f32 v36, s94, v36
    v_mul_f32 v37, s94, v37
    v_mul_f32 v38, s94, v38
    v_mul_f32 v39, s94, v39
    v_cvt_pk_bf16_f32 v57, v32, v33
    v_cvt_pk_bf16_f32 v58, v34, v35
    v_cvt_pk_bf16_f32 v59, v36, v37
    v_cvt_pk_bf16_f32 v60, v38, v39
    v_lshlrev_b32 v32, 16, v57
    v_and_b32 v33, s14, v57
    v_lshlrev_b32 v34, 16, v58
    v_and_b32 v35, s14, v58
    v_lshlrev_b32 v36, 16, v59
    v_and_b32 v37, s14, v59
    v_lshlrev_b32 v38, 16, v60
    v_and_b32 v39, s14, v60
    v_max3_f32 v61, v32, v33, v34
    v_max3_f32 v62, v35, v36, v37
    v_max3_f32 v61, v61, v38, v39
    v_max3_f32 v61, v61, v62, v6
    v_mov_b32 v62, v61
    s_nop 1
    v_permlane16_swap_b32 v61, v62
    v_max_f32 v61, v61, v62
    v_mov_b32 v62, v61
    s_nop 1
    v_permlane32_swap_b32 v61, v62
    v_max_f32 v61, v61, v62
    v_sub_f32 v56, v6, v61
    v_mul_f32 v56, s15, v56
    v_exp_f32 v56, v56
    v_mov_b32 v6, v61
    v_mul_f32 v62, s15, v61
    v_fma_f32 v32, v32, s15, -v62
    v_fma_f32 v33, v33, s15, -v62
    v_fma_f32 v34, v34, s15, -v62
    v_fma_f32 v35, v35, s15, -v62
    v_fma_f32 v36, v36, s15, -v62
    v_fma_f32 v37, v37, s15, -v62
    v_fma_f32 v38, v38, s15, -v62
    v_fma_f32 v39, v39, s15, -v62
    v_exp_f32 v32, v32
    v_exp_f32 v33, v33
    v_exp_f32 v34, v34
    v_exp_f32 v35, v35
    v_exp_f32 v36, v36
    v_exp_f32 v37, v37
    v_exp_f32 v38, v38
    v_exp_f32 v39, v39
    v_mul_f32 v7, v7, v56
    v_mul_f32_dpp v24, v56, v24 quad_perm:[0,0,0,0] row_mask:0xf bank_mask:0xf
    v_mul_f32_dpp v28, v56, v28 quad_perm:[0,0,0,0] row_mask:0xf bank_mask:0xf
    v_mul_f32_dpp v25, v56, v25 quad_perm:[1,1,1,1] row_mask:0xf bank_mask:0xf
    v_mul_f32_dpp v29, v56, v29 quad_perm:[1,1,1,1] row_mask:0xf bank_mask:0xf
    v_mul_f32_dpp v26, v56, v26 quad_perm:[2,2,2,2] row_mask:0xf bank_mask:0xf
    v_mul_f32_dpp v30, v56, v30 quad_perm:[2,2,2,2] row_mask:0xf bank_mask:0xf
    v_mul_f32_dpp v27, v56, v27 quad_perm:[3,3,3,3] row_mask:0xf bank_mask:0xf
    v_mul_f32_dpp v31, v56, v31 quad_perm:[3,3,3,3] row_mask:0xf bank_mask:0xf
    v_cvt_pk_bf16_f32 v57, v32, v33
    v_cvt_pk_bf16_f32 v58, v34, v35
    v_cvt_pk_bf16_f32 v59, v36, v37
    v_cvt_pk_bf16_f32 v60, v38, v39
    v_add_f32 v61, v32, v33
    v_add_f32 v62, v34, v35
    v_add_f32 v32, v36, v37
    v_add_f32 v33, v38, v39
    v_add_f32 v61, v61, v62
    v_add_f32 v32, v32, v33
    v_add_f32 v61, v61, v32
    v_add_f32 v7, v7, v61
    v_cndmask_b32_e64 v40, 0, v57, s[84:85]
    v_cndmask_b32_e64 v41, 0, v58, s[84:85]
    v_cndmask_b32_e64 v42, 0, v59, s[84:85]
    v_cndmask_b32_e64 v43, 0, v60, s[84:85]
    v_cndmask_b32_e64 v44, 0, v57, s[86:87]
    v_cndmask_b32_e64 v45, 0, v58, s[86:87]
    v_cndmask_b32_e64 v46, 0, v59, s[86:87]
    v_cndmask_b32_e64 v47, 0, v60, s[86:87]
    v_cndmask_b32_e64 v48, 0, v57, s[88:89]
    v_cndmask_b32_e64 v49, 0, v58, s[88:89]
    v_cndmask_b32_e64 v50, 0, v59, s[88:89]
    v_cndmask_b32_e64 v51, 0, v60, s[88:89]
    v_cndmask_b32_e64 v52, 0, v57, s[90:91]
    v_cndmask_b32_e64 v53, 0, v58, s[90:91]
    v_cndmask_b32_e64 v54, 0, v59, s[90:91]
    v_cndmask_b32_e64 v55, 0, v60, s[90:91]
    v_perm_b32 v128, v164, v160, s92
    v_perm_b32 v129, v172, v168, s92
    v_perm_b32 v130, v180, v176, s92
    v_perm_b32 v131, v188, v184, s92
    v_perm_b32 v132, v164, v160, s93
    v_perm_b32 v133, v172, v168, s93
    v_perm_b32 v134, v180, v176, s93
    v_perm_b32 v135, v188, v184, s93
    v_perm_b32 v136, v165, v161, s92
    v_perm_b32 v137, v173, v169, s92
    v_perm_b32 v138, v181, v177, s92
    v_perm_b32 v139, v189, v185, s92
    v_perm_b32 v140, v165, v161, s93
    v_perm_b32 v141, v173, v169, s93
    v_perm_b32 v142, v181, v177, s93
    v_perm_b32 v143, v189, v185, s93
    v_perm_b32 v144, v166, v162, s92
    v_perm_b32 v145, v174, v170, s92
    v_perm_b32 v146, v182, v178, s92
    v_perm_b32 v147, v190, v186, s92
    v_perm_b32 v148, v166, v162, s93
    v_perm_b32 v149, v174, v170, s93
    v_perm_b32 v150, v182, v178, s93
    v_perm_b32 v151, v190, v186, s93
    v_perm_b32 v152, v167, v163, s92
    v_perm_b32 v153, v175, v171, s92
    v_perm_b32 v154, v183, v179, s92
    v_perm_b32 v155, v191, v187, s92
    v_perm_b32 v156, v167, v163, s93
    v_perm_b32 v157, v175, v171, s93
    v_perm_b32 v158, v183, v179, s93
    v_perm_b32 v159, v191, v187, s93
    s_mov_b32 s10, 196608
    buffer_load_dwordx4 v[160:163], v4, s[44:47], s10 offen offset:0
    buffer_load_dwordx4 v[164:167], v4, s[44:47], s10 offen offset:64
    buffer_load_dwordx4 v[168:171], v4, s[44:47], s10 offen offset:128
    buffer_load_dwordx4 v[172:175], v4, s[44:47], s10 offen offset:192
    s_mov_b32 s10, 200704
    buffer_load_dwordx4 v[176:179], v4, s[44:47], s10 offen offset:0
    buffer_load_dwordx4 v[180:183], v4, s[44:47], s10 offen offset:64
    buffer_load_dwordx4 v[184:187], v4, s[44:47], s10 offen offset:128
    buffer_load_dwordx4 v[188:191], v4, s[44:47], s10 offen offset:192
    v_mfma_f32_16x16x32_bf16 v[24:27], v[40:43], v[128:131], v[24:27]
    v_mfma_f32_16x16x32_bf16 v[28:31], v[40:43], v[144:147], v[28:31]
    v_mfma_f32_16x16x32_bf16 v[24:27], v[44:47], v[132:135], v[24:27]
    v_mfma_f32_16x16x32_bf16 v[28:31], v[44:47], v[148:151], v[28:31]
    v_mfma_f32_16x16x32_bf16 v[24:27], v[48:51], v[136:139], v[24:27]
    v_mfma_f32_16x16x32_bf16 v[28:31], v[48:51], v[152:155], v[28:31]
    v_mfma_f32_16x16x32_bf16 v[24:27], v[52:55], v[140:143], v[24:27]
    v_mfma_f32_16x16x32_bf16 v[28:31], v[52:55], v[156:159], v[28:31]
    s_mov_b32 s10, 196608
    buffer_load_dwordx4 v[128:131], v5, s[48:51], s10 offen offset:0 nt
    buffer_load_dwordx4 v[132:135], v5, s[48:51], s10 offen offset:1024 nt
    buffer_load_dwordx4 v[136:139], v5, s[48:51], s10 offen offset:2048 nt
    buffer_load_dwordx4 v[140:143], v5, s[48:51], s10 offen offset:3072 nt
    s_mov_b32 s10, 200704
    buffer_load_dwordx4 v[144:147], v5, s[48:51], s10 offen offset:0 nt
    buffer_load_dwordx4 v[148:151], v5, s[48:51], s10 offen offset:1024 nt
    buffer_load_dwordx4 v[152:155], v5, s[48:51], s10 offen offset:2048 nt
    buffer_load_dwordx4 v[156:159], v5, s[48:51], s10 offen offset:3072 nt
    v_mfma_f32_16x16x32_bf16 v[32:35], v[192:195], v[8:11], 0
    v_mfma_f32_16x16x32_bf16 v[36:39], v[208:211], v[8:11], 0
    v_mfma_f32_16x16x32_bf16 v[32:35], v[196:199], v[12:15], v[32:35]
    v_mfma_f32_16x16x32_bf16 v[36:39], v[212:215], v[12:15], v[36:39]
    v_mfma_f32_16x16x32_bf16 v[32:35], v[200:203], v[16:19], v[32:35]
    v_mfma_f32_16x16x32_bf16 v[36:39], v[216:219], v[16:19], v[36:39]
    v_mfma_f32_16x16x32_bf16 v[32:35], v[204:207], v[20:23], v[32:35]
    v_mfma_f32_16x16x32_bf16 v[36:39], v[220:223], v[20:23], v[36:39]
    s_nop 7
    v_cvt_pk_bf16_f32 v57, v32, v33
    v_cvt_pk_bf16_f32 v58, v34, v35
    v_cvt_pk_bf16_f32 v59, v36, v37
    v_cvt_pk_bf16_f32 v60, v38, v39
    v_lshlrev_b32 v32, 16, v57
    v_and_b32 v33, s14, v57
    v_lshlrev_b32 v34, 16, v58
    v_and_b32 v35, s14, v58
    v_lshlrev_b32 v36, 16, v59
    v_and_b32 v37, s14, v59
    v_lshlrev_b32 v38, 16, v60
    v_and_b32 v39, s14, v60
    v_mul_f32 v32, s94, v32
    v_mul_f32 v33, s94, v33
    v_mul_f32 v34, s94, v34
    v_mul_f32 v35, s94, v35
    v_mul_f32 v36, s94, v36
    v_mul_f32 v37, s94, v37
    v_mul_f32 v38, s94, v38
    v_mul_f32 v39, s94, v39
    v_cvt_pk_bf16_f32 v57, v32, v33
    v_cvt_pk_bf16_f32 v58, v34, v35
    v_cvt_pk_bf16_f32 v59, v36, v37
    v_cvt_pk_bf16_f32 v60, v38, v39
    v_lshlrev_b32 v32, 16, v57
    v_and_b32 v33, s14, v57
    v_lshlrev_b32 v34, 16, v58
    v_and_b32 v35, s14, v58
    v_lshlrev_b32 v36, 16, v59
    v_and_b32 v37, s14, v59
    v_lshlrev_b32 v38, 16, v60
    v_and_b32 v39, s14, v60
    v_max3_f32 v61, v32, v33, v34
    v_max3_f32 v62, v35, v36, v37
    v_max3_f32 v61, v61, v38, v39
    v_max3_f32 v61, v61, v62, v6
    v_mov_b32 v62, v61
    s_nop 1
    v_permlane16_swap_b32 v61, v62
    v_max_f32 v61, v61, v62
    v_mov_b32 v62, v61
    s_nop 1
    v_permlane32_swap_b32 v61, v62
    v_max_f32 v61, v61, v62
    v_sub_f32 v56, v6, v61
    v_mul_f32 v56, s15, v56
    v_exp_f32 v56, v56
    v_mov_b32 v6, v61
    v_mul_f32 v62, s15, v61
    v_fma_f32 v32, v32, s15, -v62
    v_fma_f32 v33, v33, s15, -v62
    v_fma_f32 v34, v34, s15, -v62
    v_fma_f32 v35, v35, s15, -v62
    v_fma_f32 v36, v36, s15, -v62
    v_fma_f32 v37, v37, s15, -v62
    v_fma_f32 v38, v38, s15, -v62
    v_fma_f32 v39, v39, s15, -v62
    v_exp_f32 v32, v32
    v_exp_f32 v33, v33
    v_exp_f32 v34, v34
    v_exp_f32 v35, v35
    v_exp_f32 v36, v36
    v_exp_f32 v37, v37
    v_exp_f32 v38, v38
    v_exp_f32 v39, v39
    v_mul_f32 v7, v7, v56
    v_mul_f32_dpp v24, v56, v24 quad_perm:[0,0,0,0] row_mask:0xf bank_mask:0xf
    v_mul_f32_dpp v28, v56, v28 quad_perm:[0,0,0,0] row_mask:0xf bank_mask:0xf
    v_mul_f32_dpp v25, v56, v25 quad_perm:[1,1,1,1] row_mask:0xf bank_mask:0xf
    v_mul_f32_dpp v29, v56, v29 quad_perm:[1,1,1,1] row_mask:0xf bank_mask:0xf
    v_mul_f32_dpp v26, v56, v26 quad_perm:[2,2,2,2] row_mask:0xf bank_mask:0xf
    v_mul_f32_dpp v30, v56, v30 quad_perm:[2,2,2,2] row_mask:0xf bank_mask:0xf
    v_mul_f32_dpp v27, v56, v27 quad_perm:[3,3,3,3] row_mask:0xf bank_mask:0xf
    v_mul_f32_dpp v31, v56, v31 quad_perm:[3,3,3,3] row_mask:0xf bank_mask:0xf
    v_cvt_pk_bf16_f32 v57, v32, v33
    v_cvt_pk_bf16_f32 v58, v34, v35
    v_cvt_pk_bf16_f32 v59, v36, v37
    v_cvt_pk_bf16_f32 v60, v38, v39
    v_add_f32 v61, v32, v33
    v_add_f32 v62, v34, v35
    v_add_f32 v32, v36, v37
    v_add_f32 v33, v38, v39
    v_add_f32 v61, v61, v62
    v_add_f32 v32, v32, v33
    v_add_f32 v61, v61, v32
    v_add_f32 v7, v7, v61
    v_cndmask_b32_e64 v40, 0, v57, s[84:85]
    v_cndmask_b32_e64 v41, 0, v58, s[84:85]
    v_cndmask_b32_e64 v42, 0, v59, s[84:85]
    v_cndmask_b32_e64 v43, 0, v60, s[84:85]
    v_cndmask_b32_e64 v44, 0, v57, s[86:87]
    v_cndmask_b32_e64 v45, 0, v58, s[86:87]
    v_cndmask_b32_e64 v46, 0, v59, s[86:87]
    v_cndmask_b32_e64 v47, 0, v60, s[86:87]
    v_cndmask_b32_e64 v48, 0, v57, s[88:89]
    v_cndmask_b32_e64 v49, 0, v58, s[88:89]
    v_cndmask_b32_e64 v50, 0, v59, s[88:89]
    v_cndmask_b32_e64 v51, 0, v60, s[88:89]
    v_cndmask_b32_e64 v52, 0, v57, s[90:91]
    v_cndmask_b32_e64 v53, 0, v58, s[90:91]
    v_cndmask_b32_e64 v54, 0, v59, s[90:91]
    v_cndmask_b32_e64 v55, 0, v60, s[90:91]
    v_perm_b32 v192, v228, v224, s92
    v_perm_b32 v193, v236, v232, s92
    v_perm_b32 v194, v244, v240, s92
    v_perm_b32 v195, v252, v248, s92
    v_perm_b32 v196, v228, v224, s93
    v_perm_b32 v197, v236, v232, s93
    v_perm_b32 v198, v244, v240, s93
    v_perm_b32 v199, v252, v248, s93
    v_perm_b32 v200, v229, v225, s92
    v_perm_b32 v201, v237, v233, s92
    v_perm_b32 v202, v245, v241, s92
    v_perm_b32 v203, v253, v249, s92
    v_perm_b32 v204, v229, v225, s93
    v_perm_b32 v205, v237, v233, s93
    v_perm_b32 v206, v245, v241, s93
    v_perm_b32 v207, v253, v249, s93
    v_perm_b32 v208, v230, v226, s92
    v_perm_b32 v209, v238, v234, s92
    v_perm_b32 v210, v246, v242, s92
    v_perm_b32 v211, v254, v250, s92
    v_perm_b32 v212, v230, v226, s93
    v_perm_b32 v213, v238, v234, s93
    v_perm_b32 v214, v246, v242, s93
    v_perm_b32 v215, v254, v250, s93
    v_perm_b32 v216, v231, v227, s92
    v_perm_b32 v217, v239, v235, s92
    v_perm_b32 v218, v247, v243, s92
    v_perm_b32 v219, v255, v251, s92
    v_perm_b32 v220, v231, v227, s93
    v_perm_b32 v221, v239, v235, s93
    v_perm_b32 v222, v247, v243, s93
    v_perm_b32 v223, v255, v251, s93
    s_waitcnt vmcnt(56)
    ds_read_b128 v[224:227], v63 offset:0
    ds_read_b128 v[228:231], v63 offset:1024
    ds_read_b128 v[232:235], v63 offset:2048
    ds_read_b128 v[236:239], v63 offset:3072
    ds_read_b128 v[240:243], v63 offset:4096
    ds_read_b128 v[244:247], v63 offset:5120
    ds_read_b128 v[248:251], v63 offset:6144
    ds_read_b128 v[252:255], v63 offset:7168
    v_mfma_f32_16x16x32_bf16 v[24:27], v[40:43], v[192:195], v[24:27]
    v_mfma_f32_16x16x32_bf16 v[28:31], v[40:43], v[208:211], v[28:31]
    v_mfma_f32_16x16x32_bf16 v[24:27], v[44:47], v[196:199], v[24:27]
    v_mfma_f32_16x16x32_bf16 v[28:31], v[44:47], v[212:215], v[28:31]
    v_mfma_f32_16x16x32_bf16 v[24:27], v[48:51], v[200:203], v[24:27]
    v_mfma_f32_16x16x32_bf16 v[28:31], v[48:51], v[216:219], v[28:31]
    v_mfma_f32_16x16x32_bf16 v[24:27], v[52:55], v[204:207], v[24:27]
    v_mfma_f32_16x16x32_bf16 v[28:31], v[52:55], v[220:223], v[28:31]
    s_waitcnt vmcnt(48)
    ds_read_b128 v[192:195], v63 offset:8192
    ds_read_b128 v[196:199], v63 offset:9216
    ds_read_b128 v[200:203], v63 offset:10240
    ds_read_b128 v[204:207], v63 offset:11264
    ds_read_b128 v[208:211], v63 offset:12288
    ds_read_b128 v[212:215], v63 offset:13312
    ds_read_b128 v[216:219], v63 offset:14336
    ds_read_b128 v[220:223], v63 offset:15360
    s_waitcnt lgkmcnt(8)
    v_mfma_f32_16x16x32_bf16 v[32:35], v[224:227], v[8:11], 0
    v_mfma_f32_16x16x32_bf16 v[36:39], v[240:243], v[8:11], 0
    v_mfma_f32_16x16x32_bf16 v[32:35], v[228:231], v[12:15], v[32:35]
    v_mfma_f32_16x16x32_bf16 v[36:39], v[244:247], v[12:15], v[36:39]
    v_mfma_f32_16x16x32_bf16 v[32:35], v[232:235], v[16:19], v[32:35]
    v_mfma_f32_16x16x32_bf16 v[36:39], v[248:251], v[16:19], v[36:39]
    v_mfma_f32_16x16x32_bf16 v[32:35], v[236:239], v[20:23], v[32:35]
    v_mfma_f32_16x16x32_bf16 v[36:39], v[252:255], v[20:23], v[36:39]
    s_nop 7
    v_cvt_pk_bf16_f32 v57, v32, v33
    v_cvt_pk_bf16_f32 v58, v34, v35
    v_cvt_pk_bf16_f32 v59, v36, v37
    v_cvt_pk_bf16_f32 v60, v38, v39
    v_lshlrev_b32 v32, 16, v57
    v_and_b32 v33, s14, v57
    v_lshlrev_b32 v34, 16, v58
    v_and_b32 v35, s14, v58
    v_lshlrev_b32 v36, 16, v59
    v_and_b32 v37, s14, v59
    v_lshlrev_b32 v38, 16, v60
    v_and_b32 v39, s14, v60
    v_mul_f32 v32, s94, v32
    v_mul_f32 v33, s94, v33
    v_mul_f32 v34, s94, v34
    v_mul_f32 v35, s94, v35
    v_mul_f32 v36, s94, v36
    v_mul_f32 v37, s94, v37
    v_mul_f32 v38, s94, v38
    v_mul_f32 v39, s94, v39
    v_cvt_pk_bf16_f32 v57, v32, v33
    v_cvt_pk_bf16_f32 v58, v34, v35
    v_cvt_pk_bf16_f32 v59, v36, v37
    v_cvt_pk_bf16_f32 v60, v38, v39
    v_lshlrev_b32 v32, 16, v57
    v_and_b32 v33, s14, v57
    v_lshlrev_b32 v34, 16, v58
    v_and_b32 v35, s14, v58
    v_lshlrev_b32 v36, 16, v59
    v_and_b32 v37, s14, v59
    v_lshlrev_b32 v38, 16, v60
    v_and_b32 v39, s14, v60
    v_max3_f32 v61, v32, v33, v34
    v_max3_f32 v62, v35, v36, v37
    v_max3_f32 v61, v61, v38, v39
    v_max3_f32 v61, v61, v62, v6
    v_mov_b32 v62, v61
    s_nop 1
    v_permlane16_swap_b32 v61, v62
    v_max_f32 v61, v61, v62
    v_mov_b32 v62, v61
    s_nop 1
    v_permlane32_swap_b32 v61, v62
    v_max_f32 v61, v61, v62
    v_sub_f32 v56, v6, v61
    v_mul_f32 v56, s15, v56
    v_exp_f32 v56, v56
    v_mov_b32 v6, v61
    v_mul_f32 v62, s15, v61
    v_fma_f32 v32, v32, s15, -v62
    v_fma_f32 v33, v33, s15, -v62
    v_fma_f32 v34, v34, s15, -v62
    v_fma_f32 v35, v35, s15, -v62
    v_fma_f32 v36, v36, s15, -v62
    v_fma_f32 v37, v37, s15, -v62
    v_fma_f32 v38, v38, s15, -v62
    v_fma_f32 v39, v39, s15, -v62
    v_exp_f32 v32, v32
    v_exp_f32 v33, v33
    v_exp_f32 v34, v34
    v_exp_f32 v35, v35
    v_exp_f32 v36, v36
    v_exp_f32 v37, v37
    v_exp_f32 v38, v38
    v_exp_f32 v39, v39
    v_mul_f32 v7, v7, v56
    v_mul_f32_dpp v24, v56, v24 quad_perm:[0,0,0,0] row_mask:0xf bank_mask:0xf
    v_mul_f32_dpp v28, v56, v28 quad_perm:[0,0,0,0] row_mask:0xf bank_mask:0xf
    v_mul_f32_dpp v25, v56, v25 quad_perm:[1,1,1,1] row_mask:0xf bank_mask:0xf
    v_mul_f32_dpp v29, v56, v29 quad_perm:[1,1,1,1] row_mask:0xf bank_mask:0xf
    v_mul_f32_dpp v26, v56, v26 quad_perm:[2,2,2,2] row_mask:0xf bank_mask:0xf
    v_mul_f32_dpp v30, v56, v30 quad_perm:[2,2,2,2] row_mask:0xf bank_mask:0xf
    v_mul_f32_dpp v27, v56, v27 quad_perm:[3,3,3,3] row_mask:0xf bank_mask:0xf
    v_mul_f32_dpp v31, v56, v31 quad_perm:[3,3,3,3] row_mask:0xf bank_mask:0xf
    v_cvt_pk_bf16_f32 v57, v32, v33
    v_cvt_pk_bf16_f32 v58, v34, v35
    v_cvt_pk_bf16_f32 v59, v36, v37
    v_cvt_pk_bf16_f32 v60, v38, v39
    v_add_f32 v61, v32, v33
    v_add_f32 v62, v34, v35
    v_add_f32 v32, v36, v37
    v_add_f32 v33, v38, v39
    v_add_f32 v61, v61, v62
    v_add_f32 v32, v32, v33
    v_add_f32 v61, v61, v32
    v_add_f32 v7, v7, v61
    v_cndmask_b32_e64 v40, 0, v57, s[84:85]
    v_cndmask_b32_e64 v41, 0, v58, s[84:85]
    v_cndmask_b32_e64 v42, 0, v59, s[84:85]
    v_cndmask_b32_e64 v43, 0, v60, s[84:85]
    v_cndmask_b32_e64 v44, 0, v57, s[86:87]
    v_cndmask_b32_e64 v45, 0, v58, s[86:87]
    v_cndmask_b32_e64 v46, 0, v59, s[86:87]
    v_cndmask_b32_e64 v47, 0, v60, s[86:87]
    v_cndmask_b32_e64 v48, 0, v57, s[88:89]
    v_cndmask_b32_e64 v49, 0, v58, s[88:89]
    v_cndmask_b32_e64 v50, 0, v59, s[88:89]
    v_cndmask_b32_e64 v51, 0, v60, s[88:89]
    v_cndmask_b32_e64 v52, 0, v57, s[90:91]
    v_cndmask_b32_e64 v53, 0, v58, s[90:91]
    v_cndmask_b32_e64 v54, 0, v59, s[90:91]
    v_cndmask_b32_e64 v55, 0, v60, s[90:91]
    s_waitcnt lgkmcnt(0)
    v_perm_b32 v224, v196, v192, s92
    v_perm_b32 v225, v204, v200, s92
    v_perm_b32 v226, v212, v208, s92
    v_perm_b32 v227, v220, v216, s92
    v_perm_b32 v228, v196, v192, s93
    v_perm_b32 v229, v204, v200, s93
    v_perm_b32 v230, v212, v208, s93
    v_perm_b32 v231, v220, v216, s93
    v_perm_b32 v232, v197, v193, s92
    v_perm_b32 v233, v205, v201, s92
    v_perm_b32 v234, v213, v209, s92
    v_perm_b32 v235, v221, v217, s92
    v_perm_b32 v236, v197, v193, s93
    v_perm_b32 v237, v205, v201, s93
    v_perm_b32 v238, v213, v209, s93
    v_perm_b32 v239, v221, v217, s93
    v_perm_b32 v240, v198, v194, s92
    v_perm_b32 v241, v206, v202, s92
    v_perm_b32 v242, v214, v210, s92
    v_perm_b32 v243, v222, v218, s92
    v_perm_b32 v244, v198, v194, s93
    v_perm_b32 v245, v206, v202, s93
    v_perm_b32 v246, v214, v210, s93
    v_perm_b32 v247, v222, v218, s93
    v_perm_b32 v248, v199, v195, s92
    v_perm_b32 v249, v207, v203, s92
    v_perm_b32 v250, v215, v211, s92
    v_perm_b32 v251, v223, v219, s92
    v_perm_b32 v252, v199, v195, s93
    v_perm_b32 v253, v207, v203, s93
    v_perm_b32 v254, v215, v211, s93
    v_perm_b32 v255, v223, v219, s93
    s_waitcnt vmcnt(40)
    ds_read_b128 v[192:195], v63 offset:16384
    ds_read_b128 v[196:199], v63 offset:17408
    ds_read_b128 v[200:203], v63 offset:18432
    ds_read_b128 v[204:207], v63 offset:19456
    ds_read_b128 v[208:211], v63 offset:20480
    ds_read_b128 v[212:215], v63 offset:21504
    ds_read_b128 v[216:219], v63 offset:22528
    ds_read_b128 v[220:223], v63 offset:23552
    v_mfma_f32_16x16x32_bf16 v[24:27], v[40:43], v[224:227], v[24:27]
    v_mfma_f32_16x16x32_bf16 v[28:31], v[40:43], v[240:243], v[28:31]
    v_mfma_f32_16x16x32_bf16 v[24:27], v[44:47], v[228:231], v[24:27]
    v_mfma_f32_16x16x32_bf16 v[28:31], v[44:47], v[244:247], v[28:31]
    v_mfma_f32_16x16x32_bf16 v[24:27], v[48:51], v[232:235], v[24:27]
    v_mfma_f32_16x16x32_bf16 v[28:31], v[48:51], v[248:251], v[28:31]
    v_mfma_f32_16x16x32_bf16 v[24:27], v[52:55], v[236:239], v[24:27]
    v_mfma_f32_16x16x32_bf16 v[28:31], v[52:55], v[252:255], v[28:31]
    s_waitcnt vmcnt(32)
    ds_read_b128 v[224:227], v63 offset:24576
    ds_read_b128 v[228:231], v63 offset:25600
    ds_read_b128 v[232:235], v63 offset:26624
    ds_read_b128 v[236:239], v63 offset:27648
    ds_read_b128 v[240:243], v63 offset:28672
    ds_read_b128 v[244:247], v63 offset:29696
    ds_read_b128 v[248:251], v63 offset:30720
    ds_read_b128 v[252:255], v63 offset:31744
    s_waitcnt lgkmcnt(8)
    v_mfma_f32_16x16x32_bf16 v[32:35], v[192:195], v[8:11], 0
    v_mfma_f32_16x16x32_bf16 v[36:39], v[208:211], v[8:11], 0
    v_mfma_f32_16x16x32_bf16 v[32:35], v[196:199], v[12:15], v[32:35]
    v_mfma_f32_16x16x32_bf16 v[36:39], v[212:215], v[12:15], v[36:39]
    v_mfma_f32_16x16x32_bf16 v[32:35], v[200:203], v[16:19], v[32:35]
    v_mfma_f32_16x16x32_bf16 v[36:39], v[216:219], v[16:19], v[36:39]
    v_mfma_f32_16x16x32_bf16 v[32:35], v[204:207], v[20:23], v[32:35]
    v_mfma_f32_16x16x32_bf16 v[36:39], v[220:223], v[20:23], v[36:39]
    s_nop 7
    v_cvt_pk_bf16_f32 v57, v32, v33
    v_cvt_pk_bf16_f32 v58, v34, v35
    v_cvt_pk_bf16_f32 v59, v36, v37
    v_cvt_pk_bf16_f32 v60, v38, v39
    v_lshlrev_b32 v32, 16, v57
    v_and_b32 v33, s14, v57
    v_lshlrev_b32 v34, 16, v58
    v_and_b32 v35, s14, v58
    v_lshlrev_b32 v36, 16, v59
    v_and_b32 v37, s14, v59
    v_lshlrev_b32 v38, 16, v60
    v_and_b32 v39, s14, v60
    v_mul_f32 v32, s94, v32
    v_mul_f32 v33, s94, v33
    v_mul_f32 v34, s94, v34
    v_mul_f32 v35, s94, v35
    v_mul_f32 v36, s94, v36
    v_mul_f32 v37, s94, v37
    v_mul_f32 v38, s94, v38
    v_mul_f32 v39, s94, v39
    v_cvt_pk_bf16_f32 v57, v32, v33
    v_cvt_pk_bf16_f32 v58, v34, v35
    v_cvt_pk_bf16_f32 v59, v36, v37
    v_cvt_pk_bf16_f32 v60, v38, v39
    v_lshlrev_b32 v32, 16, v57
    v_and_b32 v33, s14, v57
    v_lshlrev_b32 v34, 16, v58
    v_and_b32 v35, s14, v58
    v_lshlrev_b32 v36, 16, v59
    v_and_b32 v37, s14, v59
    v_lshlrev_b32 v38, 16, v60
    v_and_b32 v39, s14, v60
    v_max3_f32 v61, v32, v33, v34
    v_max3_f32 v62, v35, v36, v37
    v_max3_f32 v61, v61, v38, v39
    v_max3_f32 v61, v61, v62, v6
    v_mov_b32 v62, v61
    s_nop 1
    v_permlane16_swap_b32 v61, v62
    v_max_f32 v61, v61, v62
    v_mov_b32 v62, v61
    s_nop 1
    v_permlane32_swap_b32 v61, v62
    v_max_f32 v61, v61, v62
    v_sub_f32 v56, v6, v61
    v_mul_f32 v56, s15, v56
    v_exp_f32 v56, v56
    v_mov_b32 v6, v61
    v_mul_f32 v62, s15, v61
    v_fma_f32 v32, v32, s15, -v62
    v_fma_f32 v33, v33, s15, -v62
    v_fma_f32 v34, v34, s15, -v62
    v_fma_f32 v35, v35, s15, -v62
    v_fma_f32 v36, v36, s15, -v62
    v_fma_f32 v37, v37, s15, -v62
    v_fma_f32 v38, v38, s15, -v62
    v_fma_f32 v39, v39, s15, -v62
    v_exp_f32 v32, v32
    v_exp_f32 v33, v33
    v_exp_f32 v34, v34
    v_exp_f32 v35, v35
    v_exp_f32 v36, v36
    v_exp_f32 v37, v37
    v_exp_f32 v38, v38
    v_exp_f32 v39, v39
    v_mul_f32 v7, v7, v56
    v_mul_f32_dpp v24, v56, v24 quad_perm:[0,0,0,0] row_mask:0xf bank_mask:0xf
    v_mul_f32_dpp v28, v56, v28 quad_perm:[0,0,0,0] row_mask:0xf bank_mask:0xf
    v_mul_f32_dpp v25, v56, v25 quad_perm:[1,1,1,1] row_mask:0xf bank_mask:0xf
    v_mul_f32_dpp v29, v56, v29 quad_perm:[1,1,1,1] row_mask:0xf bank_mask:0xf
    v_mul_f32_dpp v26, v56, v26 quad_perm:[2,2,2,2] row_mask:0xf bank_mask:0xf
    v_mul_f32_dpp v30, v56, v30 quad_perm:[2,2,2,2] row_mask:0xf bank_mask:0xf
    v_mul_f32_dpp v27, v56, v27 quad_perm:[3,3,3,3] row_mask:0xf bank_mask:0xf
    v_mul_f32_dpp v31, v56, v31 quad_perm:[3,3,3,3] row_mask:0xf bank_mask:0xf
    v_cvt_pk_bf16_f32 v57, v32, v33
    v_cvt_pk_bf16_f32 v58, v34, v35
    v_cvt_pk_bf16_f32 v59, v36, v37
    v_cvt_pk_bf16_f32 v60, v38, v39
    v_add_f32 v61, v32, v33
    v_add_f32 v62, v34, v35
    v_add_f32 v32, v36, v37
    v_add_f32 v33, v38, v39
    v_add_f32 v61, v61, v62
    v_add_f32 v32, v32, v33
    v_add_f32 v61, v61, v32
    v_add_f32 v7, v7, v61
    v_cndmask_b32_e64 v40, 0, v57, s[84:85]
    v_cndmask_b32_e64 v41, 0, v58, s[84:85]
    v_cndmask_b32_e64 v42, 0, v59, s[84:85]
    v_cndmask_b32_e64 v43, 0, v60, s[84:85]
    v_cndmask_b32_e64 v44, 0, v57, s[86:87]
    v_cndmask_b32_e64 v45, 0, v58, s[86:87]
    v_cndmask_b32_e64 v46, 0, v59, s[86:87]
    v_cndmask_b32_e64 v47, 0, v60, s[86:87]
    v_cndmask_b32_e64 v48, 0, v57, s[88:89]
    v_cndmask_b32_e64 v49, 0, v58, s[88:89]
    v_cndmask_b32_e64 v50, 0, v59, s[88:89]
    v_cndmask_b32_e64 v51, 0, v60, s[88:89]
    v_cndmask_b32_e64 v52, 0, v57, s[90:91]
    v_cndmask_b32_e64 v53, 0, v58, s[90:91]
    v_cndmask_b32_e64 v54, 0, v59, s[90:91]
    v_cndmask_b32_e64 v55, 0, v60, s[90:91]
    s_waitcnt lgkmcnt(0)
    v_perm_b32 v192, v228, v224, s92
    v_perm_b32 v193, v236, v232, s92
    v_perm_b32 v194, v244, v240, s92
    v_perm_b32 v195, v252, v248, s92
    v_perm_b32 v196, v228, v224, s93
    v_perm_b32 v197, v236, v232, s93
    v_perm_b32 v198, v244, v240, s93
    v_perm_b32 v199, v252, v248, s93
    v_perm_b32 v200, v229, v225, s92
    v_perm_b32 v201, v237, v233, s92
    v_perm_b32 v202, v245, v241, s92
    v_perm_b32 v203, v253, v249, s92
    v_perm_b32 v204, v229, v225, s93
    v_perm_b32 v205, v237, v233, s93
    v_perm_b32 v206, v245, v241, s93
    v_perm_b32 v207, v253, v249, s93
    v_perm_b32 v208, v230, v226, s92
    v_perm_b32 v209, v238, v234, s92
    v_perm_b32 v210, v246, v242, s92
    v_perm_b32 v211, v254, v250, s92
    v_perm_b32 v212, v230, v226, s93
    v_perm_b32 v213, v238, v234, s93
    v_perm_b32 v214, v246, v242, s93
    v_perm_b32 v215, v254, v250, s93
    v_perm_b32 v216, v231, v227, s92
    v_perm_b32 v217, v239, v235, s92
    v_perm_b32 v218, v247, v243, s92
    v_perm_b32 v219, v255, v251, s92
    v_perm_b32 v220, v231, v227, s93
    v_perm_b32 v221, v239, v235, s93
    v_perm_b32 v222, v247, v243, s93
    v_perm_b32 v223, v255, v251, s93
    s_mov_b32 s10, 229376
    buffer_load_dwordx4 v[224:227], v4, s[44:47], s10 offen offset:0
    buffer_load_dwordx4 v[228:231], v4, s[44:47], s10 offen offset:64
    buffer_load_dwordx4 v[232:235], v4, s[44:47], s10 offen offset:128
    buffer_load_dwordx4 v[236:239], v4, s[44:47], s10 offen offset:192
    s_mov_b32 s10, 233472
    buffer_load_dwordx4 v[240:243], v4, s[44:47], s10 offen offset:0
    buffer_load_dwordx4 v[244:247], v4, s[44:47], s10 offen offset:64
    buffer_load_dwordx4 v[248:251], v4, s[44:47], s10 offen offset:128
    buffer_load_dwordx4 v[252:255], v4, s[44:47], s10 offen offset:192
    v_mfma_f32_16x16x32_bf16 v[24:27], v[40:43], v[192:195], v[24:27]
    v_mfma_f32_16x16x32_bf16 v[28:31], v[40:43], v[208:211], v[28:31]
    v_mfma_f32_16x16x32_bf16 v[24:27], v[44:47], v[196:199], v[24:27]
    v_mfma_f32_16x16x32_bf16 v[28:31], v[44:47], v[212:215], v[28:31]
    v_mfma_f32_16x16x32_bf16 v[24:27], v[48:51], v[200:203], v[24:27]
    v_mfma_f32_16x16x32_bf16 v[28:31], v[48:51], v[216:219], v[28:31]
    v_mfma_f32_16x16x32_bf16 v[24:27], v[52:55], v[204:207], v[24:27]
    v_mfma_f32_16x16x32_bf16 v[28:31], v[52:55], v[220:223], v[28:31]
    s_mov_b32 s10, 229376
    buffer_load_dwordx4 v[192:195], v5, s[48:51], s10 offen offset:0 nt
    buffer_load_dwordx4 v[196:199], v5, s[48:51], s10 offen offset:1024 nt
    buffer_load_dwordx4 v[200:203], v5, s[48:51], s10 offen offset:2048 nt
    buffer_load_dwordx4 v[204:207], v5, s[48:51], s10 offen offset:3072 nt
    s_mov_b32 s10, 233472
    buffer_load_dwordx4 v[208:211], v5, s[48:51], s10 offen offset:0 nt
    buffer_load_dwordx4 v[212:215], v5, s[48:51], s10 offen offset:1024 nt
    buffer_load_dwordx4 v[216:219], v5, s[48:51], s10 offen offset:2048 nt
    buffer_load_dwordx4 v[220:223], v5, s[48:51], s10 offen offset:3072 nt
    s_waitcnt vmcnt(40)
    v_mfma_f32_16x16x32_bf16 v[32:35], v[96:99], v[8:11], 0
    v_mfma_f32_16x16x32_bf16 v[36:39], v[112:115], v[8:11], 0
    v_mfma_f32_16x16x32_bf16 v[32:35], v[100:103], v[12:15], v[32:35]
    v_mfma_f32_16x16x32_bf16 v[36:39], v[116:119], v[12:15], v[36:39]
    v_mfma_f32_16x16x32_bf16 v[32:35], v[104:107], v[16:19], v[32:35]
    v_mfma_f32_16x16x32_bf16 v[36:39], v[120:123], v[16:19], v[36:39]
    v_mfma_f32_16x16x32_bf16 v[32:35], v[108:111], v[20:23], v[32:35]
    v_mfma_f32_16x16x32_bf16 v[36:39], v[124:127], v[20:23], v[36:39]
    s_nop 7
    v_cvt_pk_bf16_f32 v57, v32, v33
    v_cvt_pk_bf16_f32 v58, v34, v35
    v_cvt_pk_bf16_f32 v59, v36, v37
    v_cvt_pk_bf16_f32 v60, v38, v39
    v_lshlrev_b32 v32, 16, v57
    v_and_b32 v33, s14, v57
    v_lshlrev_b32 v34, 16, v58
    v_and_b32 v35, s14, v58
    v_lshlrev_b32 v36, 16, v59
    v_and_b32 v37, s14, v59
    v_lshlrev_b32 v38, 16, v60
    v_and_b32 v39, s14, v60
    v_mul_f32 v32, s94, v32
    v_mul_f32 v33, s94, v33
    v_mul_f32 v34, s94, v34
    v_mul_f32 v35, s94, v35
    v_mul_f32 v36, s94, v36
    v_mul_f32 v37, s94, v37
    v_mul_f32 v38, s94, v38
    v_mul_f32 v39, s94, v39
    v_cvt_pk_bf16_f32 v57, v32, v33
    v_cvt_pk_bf16_f32 v58, v34, v35
    v_cvt_pk_bf16_f32 v59, v36, v37
    v_cvt_pk_bf16_f32 v60, v38, v39
    v_lshlrev_b32 v32, 16, v57
    v_and_b32 v33, s14, v57
    v_lshlrev_b32 v34, 16, v58
    v_and_b32 v35, s14, v58
    v_lshlrev_b32 v36, 16, v59
    v_and_b32 v37, s14, v59
    v_lshlrev_b32 v38, 16, v60
    v_and_b32 v39, s14, v60
    v_max3_f32 v61, v32, v33, v34
    v_max3_f32 v62, v35, v36, v37
    v_max3_f32 v61, v61, v38, v39
    v_max3_f32 v61, v61, v62, v6
    v_mov_b32 v62, v61
    s_nop 1
    v_permlane16_swap_b32 v61, v62
    v_max_f32 v61, v61, v62
    v_mov_b32 v62, v61
    s_nop 1
    v_permlane32_swap_b32 v61, v62
    v_max_f32 v61, v61, v62
    v_sub_f32 v56, v6, v61
    v_mul_f32 v56, s15, v56
    v_exp_f32 v56, v56
    v_mov_b32 v6, v61
    v_mul_f32 v62, s15, v61
    v_fma_f32 v32, v32, s15, -v62
    v_fma_f32 v33, v33, s15, -v62
    v_fma_f32 v34, v34, s15, -v62
    v_fma_f32 v35, v35, s15, -v62
    v_fma_f32 v36, v36, s15, -v62
    v_fma_f32 v37, v37, s15, -v62
    v_fma_f32 v38, v38, s15, -v62
    v_fma_f32 v39, v39, s15, -v62
    v_exp_f32 v32, v32
    v_exp_f32 v33, v33
    v_exp_f32 v34, v34
    v_exp_f32 v35, v35
    v_exp_f32 v36, v36
    v_exp_f32 v37, v37
    v_exp_f32 v38, v38
    v_exp_f32 v39, v39
    v_mul_f32 v7, v7, v56
    v_mul_f32_dpp v24, v56, v24 quad_perm:[0,0,0,0] row_mask:0xf bank_mask:0xf
    v_mul_f32_dpp v28, v56, v28 quad_perm:[0,0,0,0] row_mask:0xf bank_mask:0xf
    v_mul_f32_dpp v25, v56, v25 quad_perm:[1,1,1,1] row_mask:0xf bank_mask:0xf
    v_mul_f32_dpp v29, v56, v29 quad_perm:[1,1,1,1] row_mask:0xf bank_mask:0xf
    v_mul_f32_dpp v26, v56, v26 quad_perm:[2,2,2,2] row_mask:0xf bank_mask:0xf
    v_mul_f32_dpp v30, v56, v30 quad_perm:[2,2,2,2] row_mask:0xf bank_mask:0xf
    v_mul_f32_dpp v27, v56, v27 quad_perm:[3,3,3,3] row_mask:0xf bank_mask:0xf
    v_mul_f32_dpp v31, v56, v31 quad_perm:[3,3,3,3] row_mask:0xf bank_mask:0xf
    v_cvt_pk_bf16_f32 v57, v32, v33
    v_cvt_pk_bf16_f32 v58, v34, v35
    v_cvt_pk_bf16_f32 v59, v36, v37
    v_cvt_pk_bf16_f32 v60, v38, v39
    v_add_f32 v61, v32, v33
    v_add_f32 v62, v34, v35
    v_add_f32 v32, v36, v37
    v_add_f32 v33, v38, v39
    v_add_f32 v61, v61, v62
    v_add_f32 v32, v32, v33
    v_add_f32 v61, v61, v32
    v_add_f32 v7, v7, v61
    v_cndmask_b32_e64 v40, 0, v57, s[84:85]
    v_cndmask_b32_e64 v41, 0, v58, s[84:85]
    v_cndmask_b32_e64 v42, 0, v59, s[84:85]
    v_cndmask_b32_e64 v43, 0, v60, s[84:85]
    v_cndmask_b32_e64 v44, 0, v57, s[86:87]
    v_cndmask_b32_e64 v45, 0, v58, s[86:87]
    v_cndmask_b32_e64 v46, 0, v59, s[86:87]
    v_cndmask_b32_e64 v47, 0, v60, s[86:87]
    v_cndmask_b32_e64 v48, 0, v57, s[88:89]
    v_cndmask_b32_e64 v49, 0, v58, s[88:89]
    v_cndmask_b32_e64 v50, 0, v59, s[88:89]
    v_cndmask_b32_e64 v51, 0, v60, s[88:89]
    v_cndmask_b32_e64 v52, 0, v57, s[90:91]
    v_cndmask_b32_e64 v53, 0, v58, s[90:91]
    v_cndmask_b32_e64 v54, 0, v59, s[90:91]
    v_cndmask_b32_e64 v55, 0, v60, s[90:91]
    s_waitcnt vmcnt(32)
    v_perm_b32 v96, v68, v64, s92
    v_perm_b32 v97, v76, v72, s92
    v_perm_b32 v98, v84, v80, s92
    v_perm_b32 v99, v92, v88, s92
    v_perm_b32 v100, v68, v64, s93
    v_perm_b32 v101, v76, v72, s93
    v_perm_b32 v102, v84, v80, s93
    v_perm_b32 v103, v92, v88, s93
    v_perm_b32 v104, v69, v65, s92
    v_perm_b32 v105, v77, v73, s92
    v_perm_b32 v106, v85, v81, s92
    v_perm_b32 v107, v93, v89, s92
    v_perm_b32 v108, v69, v65, s93
    v_perm_b32 v109, v77, v73, s93
    v_perm_b32 v110, v85, v81, s93
    v_perm_b32 v111, v93, v89, s93
    v_perm_b32 v112, v70, v66, s92
    v_perm_b32 v113, v78, v74, s92
    v_perm_b32 v114, v86, v82, s92
    v_perm_b32 v115, v94, v90, s92
    v_perm_b32 v116, v70, v66, s93
    v_perm_b32 v117, v78, v74, s93
    v_perm_b32 v118, v86, v82, s93
    v_perm_b32 v119, v94, v90, s93
    v_perm_b32 v120, v71, v67, s92
    v_perm_b32 v121, v79, v75, s92
    v_perm_b32 v122, v87, v83, s92
    v_perm_b32 v123, v95, v91, s92
    v_perm_b32 v124, v71, v67, s93
    v_perm_b32 v125, v79, v75, s93
    v_perm_b32 v126, v87, v83, s93
    v_perm_b32 v127, v95, v91, s93
    s_nop 1
    v_mfma_f32_16x16x32_bf16 v[24:27], v[40:43], v[96:99], v[24:27]
    v_mfma_f32_16x16x32_bf16 v[28:31], v[40:43], v[112:115], v[28:31]
    v_mfma_f32_16x16x32_bf16 v[24:27], v[44:47], v[100:103], v[24:27]
    v_mfma_f32_16x16x32_bf16 v[28:31], v[44:47], v[116:119], v[28:31]
    v_mfma_f32_16x16x32_bf16 v[24:27], v[48:51], v[104:107], v[24:27]
    v_mfma_f32_16x16x32_bf16 v[28:31], v[48:51], v[120:123], v[28:31]
    v_mfma_f32_16x16x32_bf16 v[24:27], v[52:55], v[108:111], v[24:27]
    v_mfma_f32_16x16x32_bf16 v[28:31], v[52:55], v[124:127], v[28:31]
    s_waitcnt vmcnt(24)
    v_mfma_f32_16x16x32_bf16 v[32:35], v[160:163], v[8:11], 0
    v_mfma_f32_16x16x32_bf16 v[36:39], v[176:179], v[8:11], 0
    v_mfma_f32_16x16x32_bf16 v[32:35], v[164:167], v[12:15], v[32:35]
    v_mfma_f32_16x16x32_bf16 v[36:39], v[180:183], v[12:15], v[36:39]
    v_mfma_f32_16x16x32_bf16 v[32:35], v[168:171], v[16:19], v[32:35]
    v_mfma_f32_16x16x32_bf16 v[36:39], v[184:187], v[16:19], v[36:39]
    v_mfma_f32_16x16x32_bf16 v[32:35], v[172:175], v[20:23], v[32:35]
    v_mfma_f32_16x16x32_bf16 v[36:39], v[188:191], v[20:23], v[36:39]
    s_nop 7
    v_cvt_pk_bf16_f32 v57, v32, v33
    v_cvt_pk_bf16_f32 v58, v34, v35
    v_cvt_pk_bf16_f32 v59, v36, v37
    v_cvt_pk_bf16_f32 v60, v38, v39
    v_lshlrev_b32 v32, 16, v57
    v_and_b32 v33, s14, v57
    v_lshlrev_b32 v34, 16, v58
    v_and_b32 v35, s14, v58
    v_lshlrev_b32 v36, 16, v59
    v_and_b32 v37, s14, v59
    v_lshlrev_b32 v38, 16, v60
    v_and_b32 v39, s14, v60
    v_mul_f32 v32, s94, v32
    v_mul_f32 v33, s94, v33
    v_mul_f32 v34, s94, v34
    v_mul_f32 v35, s94, v35
    v_mul_f32 v36, s94, v36
    v_mul_f32 v37, s94, v37
    v_mul_f32 v38, s94, v38
    v_mul_f32 v39, s94, v39
    v_cvt_pk_bf16_f32 v57, v32, v33
    v_cvt_pk_bf16_f32 v58, v34, v35
    v_cvt_pk_bf16_f32 v59, v36, v37
    v_cvt_pk_bf16_f32 v60, v38, v39
    v_lshlrev_b32 v32, 16, v57
    v_and_b32 v33, s14, v57
    v_lshlrev_b32 v34, 16, v58
    v_and_b32 v35, s14, v58
    v_lshlrev_b32 v36, 16, v59
    v_and_b32 v37, s14, v59
    v_lshlrev_b32 v38, 16, v60
    v_and_b32 v39, s14, v60
    v_max3_f32 v61, v32, v33, v34
    v_max3_f32 v62, v35, v36, v37
    v_max3_f32 v61, v61, v38, v39
    v_max3_f32 v61, v61, v62, v6
    v_mov_b32 v62, v61
    s_nop 1
    v_permlane16_swap_b32 v61, v62
    v_max_f32 v61, v61, v62
    v_mov_b32 v62, v61
    s_nop 1
    v_permlane32_swap_b32 v61, v62
    v_max_f32 v61, v61, v62
    v_sub_f32 v56, v6, v61
    v_mul_f32 v56, s15, v56
    v_exp_f32 v56, v56
    v_mov_b32 v6, v61
    v_mul_f32 v62, s15, v61
    v_fma_f32 v32, v32, s15, -v62
    v_fma_f32 v33, v33, s15, -v62
    v_fma_f32 v34, v34, s15, -v62
    v_fma_f32 v35, v35, s15, -v62
    v_fma_f32 v36, v36, s15, -v62
    v_fma_f32 v37, v37, s15, -v62
    v_fma_f32 v38, v38, s15, -v62
    v_fma_f32 v39, v39, s15, -v62
    v_exp_f32 v32, v32
    v_exp_f32 v33, v33
    v_exp_f32 v34, v34
    v_exp_f32 v35, v35
    v_exp_f32 v36, v36
    v_exp_f32 v37, v37
    v_exp_f32 v38, v38
    v_exp_f32 v39, v39
    v_mul_f32 v7, v7, v56
    v_mul_f32_dpp v24, v56, v24 quad_perm:[0,0,0,0] row_mask:0xf bank_mask:0xf
    v_mul_f32_dpp v28, v56, v28 quad_perm:[0,0,0,0] row_mask:0xf bank_mask:0xf
    v_mul_f32_dpp v25, v56, v25 quad_perm:[1,1,1,1] row_mask:0xf bank_mask:0xf
    v_mul_f32_dpp v29, v56, v29 quad_perm:[1,1,1,1] row_mask:0xf bank_mask:0xf
    v_mul_f32_dpp v26, v56, v26 quad_perm:[2,2,2,2] row_mask:0xf bank_mask:0xf
    v_mul_f32_dpp v30, v56, v30 quad_perm:[2,2,2,2] row_mask:0xf bank_mask:0xf
    v_mul_f32_dpp v27, v56, v27 quad_perm:[3,3,3,3] row_mask:0xf bank_mask:0xf
    v_mul_f32_dpp v31, v56, v31 quad_perm:[3,3,3,3] row_mask:0xf bank_mask:0xf
    v_cvt_pk_bf16_f32 v57, v32, v33
    v_cvt_pk_bf16_f32 v58, v34, v35
    v_cvt_pk_bf16_f32 v59, v36, v37
    v_cvt_pk_bf16_f32 v60, v38, v39
    v_add_f32 v61, v32, v33
    v_add_f32 v62, v34, v35
    v_add_f32 v32, v36, v37
    v_add_f32 v33, v38, v39
    v_add_f32 v61, v61, v62
    v_add_f32 v32, v32, v33
    v_add_f32 v61, v61, v32
    v_add_f32 v7, v7, v61
    v_cndmask_b32_e64 v40, 0, v57, s[84:85]
    v_cndmask_b32_e64 v41, 0, v58, s[84:85]
    v_cndmask_b32_e64 v42, 0, v59, s[84:85]
    v_cndmask_b32_e64 v43, 0, v60, s[84:85]
    v_cndmask_b32_e64 v44, 0, v57, s[86:87]
    v_cndmask_b32_e64 v45, 0, v58, s[86:87]
    v_cndmask_b32_e64 v46, 0, v59, s[86:87]
    v_cndmask_b32_e64 v47, 0, v60, s[86:87]
    v_cndmask_b32_e64 v48, 0, v57, s[88:89]
    v_cndmask_b32_e64 v49, 0, v58, s[88:89]
    v_cndmask_b32_e64 v50, 0, v59, s[88:89]
    v_cndmask_b32_e64 v51, 0, v60, s[88:89]
    v_cndmask_b32_e64 v52, 0, v57, s[90:91]
    v_cndmask_b32_e64 v53, 0, v58, s[90:91]
    v_cndmask_b32_e64 v54, 0, v59, s[90:91]
    v_cndmask_b32_e64 v55, 0, v60, s[90:91]
    s_waitcnt vmcnt(16)
    v_perm_b32 v160, v132, v128, s92
    v_perm_b32 v161, v140, v136, s92
    v_perm_b32 v162, v148, v144, s92
    v_perm_b32 v163, v156, v152, s92
    v_perm_b32 v164, v132, v128, s93
    v_perm_b32 v165, v140, v136, s93
    v_perm_b32 v166, v148, v144, s93
    v_perm_b32 v167, v156, v152, s93
    v_perm_b32 v168, v133, v129, s92
    v_perm_b32 v169, v141, v137, s92
    v_perm_b32 v170, v149, v145, s92
    v_perm_b32 v171, v157, v153, s92
    v_perm_b32 v172, v133, v129, s93
    v_perm_b32 v173, v141, v137, s93
    v_perm_b32 v174, v149, v145, s93
    v_perm_b32 v175, v157, v153, s93
    v_perm_b32 v176, v134, v130, s92
    v_perm_b32 v177, v142, v138, s92
    v_perm_b32 v178, v150, v146, s92
    v_perm_b32 v179, v158, v154, s92
    v_perm_b32 v180, v134, v130, s93
    v_perm_b32 v181, v142, v138, s93
    v_perm_b32 v182, v150, v146, s93
    v_perm_b32 v183, v158, v154, s93
    v_perm_b32 v184, v135, v131, s92
    v_perm_b32 v185, v143, v139, s92
    v_perm_b32 v186, v151, v147, s92
    v_perm_b32 v187, v159, v155, s92
    v_perm_b32 v188, v135, v131, s93
    v_perm_b32 v189, v143, v139, s93
    v_perm_b32 v190, v151, v147, s93
    v_perm_b32 v191, v159, v155, s93
    s_nop 1
    v_mfma_f32_16x16x32_bf16 v[24:27], v[40:43], v[160:163], v[24:27]
    v_mfma_f32_16x16x32_bf16 v[28:31], v[40:43], v[176:179], v[28:31]
    v_mfma_f32_16x16x32_bf16 v[24:27], v[44:47], v[164:167], v[24:27]
    v_mfma_f32_16x16x32_bf16 v[28:31], v[44:47], v[180:183], v[28:31]
    v_mfma_f32_16x16x32_bf16 v[24:27], v[48:51], v[168:171], v[24:27]
    v_mfma_f32_16x16x32_bf16 v[28:31], v[48:51], v[184:187], v[28:31]
    v_mfma_f32_16x16x32_bf16 v[24:27], v[52:55], v[172:175], v[24:27]
    v_mfma_f32_16x16x32_bf16 v[28:31], v[52:55], v[188:191], v[28:31]
    s_waitcnt vmcnt(8)
    v_mfma_f32_16x16x32_bf16 v[32:35], v[224:227], v[8:11], 0
    v_mfma_f32_16x16x32_bf16 v[36:39], v[240:243], v[8:11], 0
    v_mfma_f32_16x16x32_bf16 v[32:35], v[228:231], v[12:15], v[32:35]
    v_mfma_f32_16x16x32_bf16 v[36:39], v[244:247], v[12:15], v[36:39]
    v_mfma_f32_16x16x32_bf16 v[32:35], v[232:235], v[16:19], v[32:35]
    v_mfma_f32_16x16x32_bf16 v[36:39], v[248:251], v[16:19], v[36:39]
    v_mfma_f32_16x16x32_bf16 v[32:35], v[236:239], v[20:23], v[32:35]
    v_mfma_f32_16x16x32_bf16 v[36:39], v[252:255], v[20:23], v[36:39]
    s_nop 7
    v_cvt_pk_bf16_f32 v57, v32, v33
    v_cvt_pk_bf16_f32 v58, v34, v35
    v_cvt_pk_bf16_f32 v59, v36, v37
    v_cvt_pk_bf16_f32 v60, v38, v39
    v_lshlrev_b32 v32, 16, v57
    v_and_b32 v33, s14, v57
    v_lshlrev_b32 v34, 16, v58
    v_and_b32 v35, s14, v58
    v_lshlrev_b32 v36, 16, v59
    v_and_b32 v37, s14, v59
    v_lshlrev_b32 v38, 16, v60
    v_and_b32 v39, s14, v60
    v_mul_f32 v32, s94, v32
    v_mul_f32 v33, s94, v33
    v_mul_f32 v34, s94, v34
    v_mul_f32 v35, s94, v35
    v_mul_f32 v36, s94, v36
    v_mul_f32 v37, s94, v37
    v_mul_f32 v38, s94, v38
    v_mul_f32 v39, s94, v39
    v_cvt_pk_bf16_f32 v57, v32, v33
    v_cvt_pk_bf16_f32 v58, v34, v35
    v_cvt_pk_bf16_f32 v59, v36, v37
    v_cvt_pk_bf16_f32 v60, v38, v39
    v_lshlrev_b32 v32, 16, v57
    v_and_b32 v33, s14, v57
    v_lshlrev_b32 v34, 16, v58
    v_and_b32 v35, s14, v58
    v_lshlrev_b32 v36, 16, v59
    v_and_b32 v37, s14, v59
    v_lshlrev_b32 v38, 16, v60
    v_and_b32 v39, s14, v60
    v_max3_f32 v61, v32, v33, v34
    v_max3_f32 v62, v35, v36, v37
    v_max3_f32 v61, v61, v38, v39
    v_max3_f32 v61, v61, v62, v6
    v_mov_b32 v62, v61
    s_nop 1
    v_permlane16_swap_b32 v61, v62
    v_max_f32 v61, v61, v62
    v_mov_b32 v62, v61
    s_nop 1
    v_permlane32_swap_b32 v61, v62
    v_max_f32 v61, v61, v62
    v_sub_f32 v56, v6, v61
    v_mul_f32 v56, s15, v56
    v_exp_f32 v56, v56
    v_mov_b32 v6, v61
    v_mul_f32 v62, s15, v61
    v_fma_f32 v32, v32, s15, -v62
    v_fma_f32 v33, v33, s15, -v62
    v_fma_f32 v34, v34, s15, -v62
    v_fma_f32 v35, v35, s15, -v62
    v_fma_f32 v36, v36, s15, -v62
    v_fma_f32 v37, v37, s15, -v62
    v_fma_f32 v38, v38, s15, -v62
    v_fma_f32 v39, v39, s15, -v62
    v_exp_f32 v32, v32
    v_exp_f32 v33, v33
    v_exp_f32 v34, v34
    v_exp_f32 v35, v35
    v_exp_f32 v36, v36
    v_exp_f32 v37, v37
    v_exp_f32 v38, v38
    v_exp_f32 v39, v39
    v_mul_f32 v7, v7, v56
    v_mul_f32_dpp v24, v56, v24 quad_perm:[0,0,0,0] row_mask:0xf bank_mask:0xf
    v_mul_f32_dpp v28, v56, v28 quad_perm:[0,0,0,0] row_mask:0xf bank_mask:0xf
    v_mul_f32_dpp v25, v56, v25 quad_perm:[1,1,1,1] row_mask:0xf bank_mask:0xf
    v_mul_f32_dpp v29, v56, v29 quad_perm:[1,1,1,1] row_mask:0xf bank_mask:0xf
    v_mul_f32_dpp v26, v56, v26 quad_perm:[2,2,2,2] row_mask:0xf bank_mask:0xf
    v_mul_f32_dpp v30, v56, v30 quad_perm:[2,2,2,2] row_mask:0xf bank_mask:0xf
    v_mul_f32_dpp v27, v56, v27 quad_perm:[3,3,3,3] row_mask:0xf bank_mask:0xf
    v_mul_f32_dpp v31, v56, v31 quad_perm:[3,3,3,3] row_mask:0xf bank_mask:0xf
    v_cvt_pk_bf16_f32 v57, v32, v33
    v_cvt_pk_bf16_f32 v58, v34, v35
    v_cvt_pk_bf16_f32 v59, v36, v37
    v_cvt_pk_bf16_f32 v60, v38, v39
    v_add_f32 v61, v32, v33
    v_add_f32 v62, v34, v35
    v_add_f32 v32, v36, v37
    v_add_f32 v33, v38, v39
    v_add_f32 v61, v61, v62
    v_add_f32 v32, v32, v33
    v_add_f32 v61, v61, v32
    v_add_f32 v7, v7, v61
    v_cndmask_b32_e64 v40, 0, v57, s[84:85]
    v_cndmask_b32_e64 v41, 0, v58, s[84:85]
    v_cndmask_b32_e64 v42, 0, v59, s[84:85]
    v_cndmask_b32_e64 v43, 0, v60, s[84:85]
    v_cndmask_b32_e64 v44, 0, v57, s[86:87]
    v_cndmask_b32_e64 v45, 0, v58, s[86:87]
    v_cndmask_b32_e64 v46, 0, v59, s[86:87]
    v_cndmask_b32_e64 v47, 0, v60, s[86:87]
    v_cndmask_b32_e64 v48, 0, v57, s[88:89]
    v_cndmask_b32_e64 v49, 0, v58, s[88:89]
    v_cndmask_b32_e64 v50, 0, v59, s[88:89]
    v_cndmask_b32_e64 v51, 0, v60, s[88:89]
    v_cndmask_b32_e64 v52, 0, v57, s[90:91]
    v_cndmask_b32_e64 v53, 0, v58, s[90:91]
    v_cndmask_b32_e64 v54, 0, v59, s[90:91]
    v_cndmask_b32_e64 v55, 0, v60, s[90:91]
    s_waitcnt vmcnt(0)
    v_perm_b32 v224, v196, v192, s92
    v_perm_b32 v225, v204, v200, s92
    v_perm_b32 v226, v212, v208, s92
    v_perm_b32 v227, v220, v216, s92
    v_perm_b32 v228, v196, v192, s93
    v_perm_b32 v229, v204, v200, s93
    v_perm_b32 v230, v212, v208, s93
    v_perm_b32 v231, v220, v216, s93
    v_perm_b32 v232, v197, v193, s92
    v_perm_b32 v233, v205, v201, s92
    v_perm_b32 v234, v213, v209, s92
    v_perm_b32 v235, v221, v217, s92
    v_perm_b32 v236, v197, v193, s93
    v_perm_b32 v237, v205, v201, s93
    v_perm_b32 v238, v213, v209, s93
    v_perm_b32 v239, v221, v217, s93
    v_perm_b32 v240, v198, v194, s92
    v_perm_b32 v241, v206, v202, s92
    v_perm_b32 v242, v214, v210, s92
    v_perm_b32 v243, v222, v218, s92
    v_perm_b32 v244, v198, v194, s93
    v_perm_b32 v245, v206, v202, s93
    v_perm_b32 v246, v214, v210, s93
    v_perm_b32 v247, v222, v218, s93
    v_perm_b32 v248, v199, v195, s92
    v_perm_b32 v249, v207, v203, s92
    v_perm_b32 v250, v215, v211, s92
    v_perm_b32 v251, v223, v219, s92
    v_perm_b32 v252, v199, v195, s93
    v_perm_b32 v253, v207, v203, s93
    v_perm_b32 v254, v215, v211, s93
    v_perm_b32 v255, v223, v219, s93
    s_nop 1
    v_mfma_f32_16x16x32_bf16 v[24:27], v[40:43], v[224:227], v[24:27]
    v_mfma_f32_16x16x32_bf16 v[28:31], v[40:43], v[240:243], v[28:31]
    v_mfma_f32_16x16x32_bf16 v[24:27], v[44:47], v[228:231], v[24:27]
    v_mfma_f32_16x16x32_bf16 v[28:31], v[44:47], v[244:247], v[28:31]
    v_mfma_f32_16x16x32_bf16 v[24:27], v[48:51], v[232:235], v[24:27]
    v_mfma_f32_16x16x32_bf16 v[28:31], v[48:51], v[248:251], v[28:31]
    v_mfma_f32_16x16x32_bf16 v[24:27], v[52:55], v[236:239], v[24:27]
    v_mfma_f32_16x16x32_bf16 v[28:31], v[52:55], v[252:255], v[28:31]
L_att_done:
    v_mov_b32 v57, v7
    s_nop 1
    v_permlane16_swap_b32 v7, v57
    v_add_f32 v7, v7, v57
    v_mov_b32 v57, v7
    s_nop 1
    v_permlane32_swap_b32 v7, v57
    v_add_f32 v7, v7, v57
    v_lshlrev_b32 v57, 5, v2
    v_lshlrev_b32 v58, 2, v3
    v_add_u32 v57, v57, v58
    s_lshl_b32 s8, s7, 11
    s_add_u32 s8, s8, 1536
    v_add_u32 v57, s8, v57
    v_add_u32 v58, 1024, v57
    s_lshl_b32 s8, s7, 3
    s_add_u32 s8, s8, 1280
    v_lshlrev_b32 v59, 5, v0
    v_add_u32 v59, s8, v59
    s_nop 1
    ds_write2_b32 v57, v24, v28 offset0:0 offset1:4
    ds_write2_b32 v57, v25, v29 offset0:128 offset1:132
    ds_write2_b32 v58, v26, v30 offset0:0 offset1:4
    ds_write2_b32 v58, v27, v31 offset0:128 offset1:132
    s_mov_b32 exec_lo, 0xf
    s_mov_b32 exec_hi, 0x0
    ds_write_b64 v59, v[6:7]
    s_mov_b64 exec, -1
    s_waitcnt lgkmcnt(0)
    s_barrier
    s_cmp_lg_u32 s7, 0
    s_cbranch_scc1 L_exit
    v_lshlrev_b32 v57, 5, v3
    v_lshlrev_b32 v58, 9, v3
    v_lshlrev_b32 v59, 5, v2
    v_add_u32 v58, v58, v59
    ds_read_b128 v[64:67], v57 offset:1280
    ds_read_b128 v[68:71], v57 offset:1296
    ds_read_b128 v[72:75], v58 offset:1536
    ds_read_b128 v[76:79], v58 offset:1552
    ds_read_b128 v[80:83], v58 offset:3584
    ds_read_b128 v[84:87], v58 offset:3600
    ds_read_b128 v[88:91], v58 offset:5632
    ds_read_b128 v[92:95], v58 offset:5648
    ds_read_b128 v[96:99], v58 offset:7680
    ds_read_b128 v[100:103], v58 offset:7696
    s_lshl_b32 s8, s2, 10
    s_add_u32 s8, s8, 131072
    s_lshl_b32 s9, s95, 7
    s_lshl_b32 s10, s6, 2
    s_add_u32 s9, s9, s10
    s_add_u32 s9, s9, 393216
    v_lshlrev_b32 v60, 5, v3
    s_waitcnt lgkmcnt(8)
    v_max3_f32 v48, v64, v66, v68
    v_max_f32 v48, v48, v70
    v_sub_f32 v49, v64, v48
    v_sub_f32 v50, v66, v48
    v_sub_f32 v51, v68, v48
    v_sub_f32 v52, v70, v48
    v_mul_f32 v49, s15, v49
    v_mul_f32 v50, s15, v50
    v_mul_f32 v51, s15, v51
    v_mul_f32 v52, s15, v52
    v_exp_f32 v49, v49
    v_exp_f32 v50, v50
    v_exp_f32 v51, v51
    v_exp_f32 v52, v52
    v_mul_f32 v48, s15, v48
    v_mul_f32 v53, v49, v65
    v_fma_f32 v53, v50, v67, v53
    v_fma_f32 v53, v51, v69, v53
    v_fma_f32 v53, v52, v71, v53
    v_rcp_f32 v54, v53
    v_log_f32 v53, v53
    s_nop 0
    v_mul_f32 v49, v49, v54
    v_mul_f32 v50, v50, v54
    v_mul_f32 v51, v51, v54
    v_mul_f32 v52, v52, v54
    v_add_f32 v48, v48, v53
    s_waitcnt lgkmcnt(0)
    v_mul_f32 v72, v49, v72
    v_mul_f32 v73, v49, v73
    v_mul_f32 v74, v49, v74
    v_mul_f32 v75, v49, v75
    v_mul_f32 v76, v49, v76
    v_mul_f32 v77, v49, v77
    v_mul_f32 v78, v49, v78
    v_mul_f32 v79, v49, v79
    v_fma_f32 v72, v50, v80, v72
    v_fma_f32 v73, v50, v81, v73
    v_fma_f32 v74, v50, v82, v74
    v_fma_f32 v75, v50, v83, v75
    v_fma_f32 v76, v50, v84, v76
    v_fma_f32 v77, v50, v85, v77
    v_fma_f32 v78, v50, v86, v78
    v_fma_f32 v79, v50, v87, v79
    v_fma_f32 v72, v51, v88, v72
    v_fma_f32 v73, v51, v89, v73
    v_fma_f32 v74, v51, v90, v74
    v_fma_f32 v75, v51, v91, v75
    v_fma_f32 v76, v51, v92, v76
    v_fma_f32 v77, v51, v93, v77
    v_fma_f32 v78, v51, v94, v78
    v_fma_f32 v79, v51, v95, v79
    v_fma_f32 v72, v52, v96, v72
    v_fma_f32 v73, v52, v97, v73
    v_fma_f32 v74, v52, v98, v74
    v_fma_f32 v75, v52, v99, v75
    v_fma_f32 v76, v52, v100, v76
    v_fma_f32 v77, v52, v101, v77
    v_fma_f32 v78, v52, v102, v78
    v_fma_f32 v79, v52, v103, v79
    v_cvt_pk_bf16_f32 v64, v72, v73
    v_cvt_pk_bf16_f32 v65, v74, v75
    v_cvt_pk_bf16_f32 v66, v76, v77
    v_cvt_pk_bf16_f32 v67, v78, v79
    buffer_store_dwordx4 v[64:67], v5, s[52:55], s8 offen sc1
    s_mov_b32 exec_lo, 0x10001
    s_mov_b32 exec_hi, 0x10001
    buffer_store_dword v48, v60, s[52:55], s9 offen sc1
    s_sub_u32 s10, s3, 176
    s_cmp_ge_u32 s10, 64
    s_cbranch_scc1 L_noeb
    s_and_b32 s10, s3, 7
    s_cmp_eq_u32 s10, 7
    s_cbranch_scc1 L_noeb
    s_barrier
L_noeb:
    s_endpgm
L_service:
    s_setprio 3
    s_sub_u32 s7, s7, 4
    v_lshlrev_b32 v25, 4, v0
    v_lshlrev_b32 v26, 2, v0
    v_lshlrev_b32 v27, 3, v0
    v_mov_b32 v28, 0
    s_mov_b64 exec, 0xffff
    ds_write_b32 v26, v28 offset:0
    s_mov_b64 exec, -1
    v_mov_b32 v8, -1
    v_mov_b32 v9, -1
    v_mov_b32 v10, -1
    v_mov_b32 v11, -1
    s_lshl_b32 s8, s2, 10
    s_add_u32 s8, s8, 131072
    s_lshl_b32 s9, s2, 11
    s_add_u32 s9, s9, 523264
    s_lshl_b32 s10, s7, 10
    s_add_u32 s9, s9, s10
    s_cmp_eq_u32 s7, 0
    s_cselect_b32 s8, s8, s9
    s_lshl_b32 s9, s2, 8
    s_add_u32 s9, s9, 458752
    s_lshl_b32 s10, s2, 4
    s_add_u32 s10, s10, 393216
    s_cmp_eq_u32 s7, 3
    s_cselect_b32 s8, s9, s8
    s_cselect_b32 s100, 0x1ffff, -1
    s_cselect_b32 s101, 0, -1
    v_add_u32 v29, s8, v25
    s_cbranch_scc0 L_nw3
    v_writelane_b32 v29, s10, 16
L_nw3:
    s_and_b32 s90, s3, 7
    s_waitcnt lgkmcnt(0)
    s_barrier
    s_load_dword s12, s[42:43], 0
    s_mov_b32 s44, s42
    s_mov_b32 s45, s43
    s_mov_b32 s46, 2097152
    s_mov_b32 s47, 0x20000
    s_cmp_lt_u32 s3, 48
    s_cbranch_scc1 L_mod
    s_cmp_lt_u32 s3, 112
    s_cbranch_scc1 L_q
    s_cmp_lt_u32 s3, 176
    s_cbranch_scc1 L_wo
    s_cmp_ge_u32 s3, 240
    s_cbranch_scc1 L_none
    s_cmp_eq_u32 s90, 7
    s_cbranch_scc1 L_none
    s_branch L_ffn
L_mod:
    s_mov_b32 s52, s34
    s_mov_b32 s53, s35
    s_mov_b32 s54, 4096
    s_mov_b32 s55, 0x20000
    s_mov_b32 s56, s36
    s_mov_b32 s57, s37
    s_mov_b32 s58, 3145728
    s_mov_b32 s59, 0x20000
    s_lshl_b32 s8, s7, 7
    v_lshrrev_b32 v5, 3, v2
    v_lshlrev_b32 v5, 5, v5
    v_lshlrev_b32 v6, 3, v3
    v_add3_u32 v5, v5, v6, s8
    v_and_b32 v6, 7, v2
    v_lshlrev_b32 v6, 4, v6
    s_movk_i32 s9, 6144
    v_mul_lo_u32 v24, v5, s9
    v_add_u32 v24, v24, v6
    v_and_b32 v4, 4, v2
    v_lshlrev_b32 v4, 4, v4
    v_add_u32 v4, v4, v5
    v_and_b32 v32, 3, v2
    v_lshlrev_b32 v32, 10, v32
    v_lshlrev_b32 v33, 1, v4
    v_add_u32 v32, v32, v33
    s_lshl_b32 s99, s3, 7
    buffer_load_dwordx4 v[16:19], v32, s[52:55], 0 offen
    buffer_load_dwordx4 v[128:131], v24, s[56:59], s99 offen offset:0 nt
    s_add_u32 s99, s99, 6144
    buffer_load_dwordx4 v[132:135], v24, s[56:59], s99 offen offset:0 nt
    s_add_u32 s99, s99, 6144
    buffer_load_dwordx4 v[136:139], v24, s[56:59], s99 offen offset:0 nt
    s_add_u32 s99, s99, 6144
    buffer_load_dwordx4 v[140:143], v24, s[56:59], s99 offen offset:0 nt
    s_add_u32 s99, s99, 6144
    buffer_load_dwordx4 v[144:147], v24, s[56:59], s99 offen offset:0 nt
    s_add_u32 s99, s99, 6144
    buffer_load_dwordx4 v[148:151], v24, s[56:59], s99 offen offset:0 nt
    s_add_u32 s99, s99, 6144
    buffer_load_dwordx4 v[152:155], v24, s[56:59], s99 offen offset:0 nt
    s_add_u32 s99, s99, 6144
    buffer_load_dwordx4 v[156:159], v24, s[56:59], s99 offen offset:0 nt
    s_add_u32 s99, s99, 350208
    buffer_load_dwordx4 v[160:163], v24, s[56:59], s99 offen offset:0 nt
    s_add_u32 s99, s99, 6144
    buffer_load_dwordx4 v[164:167], v24, s[56:59], s99 offen offset:0 nt
    s_add_u32 s99, s99, 6144
    buffer_load_dwordx4 v[168:171], v24, s[56:59], s99 offen offset:0 nt
    s_add_u32 s99, s99, 6144
    buffer_load_dwordx4 v[172:175], v24, s[56:59], s99 offen offset:0 nt
    s_add_u32 s99, s99, 6144
    buffer_load_dwordx4 v[176:179], v24, s[56:59], s99 offen offset:0 nt
    s_add_u32 s99, s99, 6144
    buffer_load_dwordx4 v[180:183], v24, s[56:59], s99 offen offset:0 nt
    s_add_u32 s99, s99, 6144
    buffer_load_dwordx4 v[184:187], v24, s[56:59], s99 offen offset:0 nt
    s_add_u32 s99, s99, 6144
    buffer_load_dwordx4 v[188:191], v24, s[56:59], s99 offen offset:0 nt
    s_mov_b64 exec, s[100:101]
    buffer_store_dwordx4 v[8:11], v29, s[44:47], 0 offen sc1
    s_mov_b64 exec, -1
    s_lshl_b32 s8, s7, 11
    s_add_u32 s8, s8, 9728
    v_lshrrev_b32 v30, 1, v3
    v_lshlrev_b32 v30, 10, v30
    v_lshlrev_b32 v31, 3, v6
    v_add3_u32 v30, v30, v31, s8
    s_lshl_b32 s8, s7, 2
    s_add_u32 s8, s8, 9728
    v_add_u32 v31, s8, v25
    s_waitcnt lgkmcnt(0)
    s_add_u32 s12, s12, 0x9E3779B9
    s_mul_i32 s97, s7, 12288
    s_lshl_b32 s11, s3, 8
    s_add_u32 s97, s97, s11
    s_add_u32 s97, s97, 4096
    s_waitcnt vmcnt(17)
    v_lshlrev_b32 v64, 16, v16
    v_and_b32 v65, s14, v16
    v_lshlrev_b32 v66, 16, v17
    v_and_b32 v67, s14, v17
    v_lshlrev_b32 v68, 16, v18
    v_and_b32 v69, s14, v18
    v_lshlrev_b32 v70, 16, v19
    v_and_b32 v71, s14, v19
    s_mov_b32 s8, 0xbfb8aa3b
    v_mul_f32 v72, s8, v64
    v_mul_f32 v73, s8, v65
    v_mul_f32 v74, s8, v66
    v_mul_f32 v75, s8, v67
    v_mul_f32 v76, s8, v68
    v_mul_f32 v77, s8, v69
    v_mul_f32 v78, s8, v70
    v_mul_f32 v79, s8, v71
    v_exp_f32 v72, v72
    v_exp_f32 v73, v73
    v_exp_f32 v74, v74
    v_exp_f32 v75, v75
    v_exp_f32 v76, v76
    v_exp_f32 v77, v77
    v_exp_f32 v78, v78
    v_exp_f32 v79, v79
    v_add_f32 v72, 1.0, v72
    v_add_f32 v73, 1.0, v73
    v_add_f32 v74, 1.0, v74
    v_add_f32 v75, 1.0, v75
    v_add_f32 v76, 1.0, v76
    v_add_f32 v77, 1.0, v77
    v_add_f32 v78, 1.0, v78
    v_add_f32 v79, 1.0, v79
    v_rcp_f32 v72, v72
    v_rcp_f32 v73, v73
    v_rcp_f32 v74, v74
    v_rcp_f32 v75, v75
    v_rcp_f32 v76, v76
    v_rcp_f32 v77, v77
    v_rcp_f32 v78, v78
    v_rcp_f32 v79, v79
    v_mul_f32 v64, v64, v72
    v_mul_f32 v65, v65, v73
    v_mul_f32 v66, v66, v74
    v_mul_f32 v67, v67, v75
    v_mul_f32 v68, v68, v76
    v_mul_f32 v69, v69, v77
    v_mul_f32 v70, v70, v78
    v_mul_f32 v71, v71, v79
    v_cvt_pk_bf16_f32 v16, v64, v65
    v_cvt_pk_bf16_f32 v17, v66, v67
    v_cvt_pk_bf16_f32 v18, v68, v69
    v_cvt_pk_bf16_f32 v19, v70, v71
    s_waitcnt vmcnt(9)
    v_perm_b32 v192, v132, v128, s92
    v_perm_b32 v193, v140, v136, s92
    v_perm_b32 v194, v148, v144, s92
    v_perm_b32 v195, v156, v152, s92
    v_perm_b32 v196, v132, v128, s93
    v_perm_b32 v197, v140, v136, s93
    v_perm_b32 v198, v148, v144, s93
    v_perm_b32 v199, v156, v152, s93
    v_perm_b32 v200, v133, v129, s92
    v_perm_b32 v201, v141, v137, s92
    v_perm_b32 v202, v149, v145, s92
    v_perm_b32 v203, v157, v153, s92
    v_perm_b32 v204, v133, v129, s93
    v_perm_b32 v205, v141, v137, s93
    v_perm_b32 v206, v149, v145, s93
    v_perm_b32 v207, v157, v153, s93
    v_perm_b32 v208, v134, v130, s92
    v_perm_b32 v209, v142, v138, s92
    v_perm_b32 v210, v150, v146, s92
    v_perm_b32 v211, v158, v154, s92
    v_perm_b32 v212, v134, v130, s93
    v_perm_b32 v213, v142, v138, s93
    v_perm_b32 v214, v150, v146, s93
    v_perm_b32 v215, v158, v154, s93
    v_perm_b32 v216, v135, v131, s92
    v_perm_b32 v217, v143, v139, s92
    v_perm_b32 v218, v151, v147, s92
    v_perm_b32 v219, v159, v155, s92
    v_perm_b32 v220, v135, v131, s93
    v_perm_b32 v221, v143, v139, s93
    v_perm_b32 v222, v151, v147, s93
    v_perm_b32 v223, v159, v155, s93
    s_waitcnt vmcnt(1)
    v_perm_b32 v128, v164, v160, s92
    v_perm_b32 v129, v172, v168, s92
    v_perm_b32 v130, v180, v176, s92
    v_perm_b32 v131, v188, v184, s92
    v_perm_b32 v132, v164, v160, s93
    v_perm_b32 v133, v172, v168, s93
    v_perm_b32 v134, v180, v176, s93
    v_perm_b32 v135, v188, v184, s93
    v_perm_b32 v136, v165, v161, s92
    v_perm_b32 v137, v173, v169, s92
    v_perm_b32 v138, v181, v177, s92
    v_perm_b32 v139, v189, v185, s92
    v_perm_b32 v140, v165, v161, s93
    v_perm_b32 v141, v173, v169, s93
    v_perm_b32 v142, v181, v177, s93
    v_perm_b32 v143, v189, v185, s93
    v_perm_b32 v144, v166, v162, s92
    v_perm_b32 v145, v174, v170, s92
    v_perm_b32 v146, v182, v178, s92
    v_perm_b32 v147, v190, v186, s92
    v_perm_b32 v148, v166, v162, s93
    v_perm_b32 v149, v174, v170, s93
    v_perm_b32 v150, v182, v178, s93
    v_perm_b32 v151, v190, v186, s93
    v_perm_b32 v152, v167, v163, s92
    v_perm_b32 v153, v175, v171, s92
    v_perm_b32 v154, v183, v179, s92
    v_perm_b32 v155, v191, v187, s92
    v_perm_b32 v156, v167, v163, s93
    v_perm_b32 v157, v175, v171, s93
    v_perm_b32 v158, v183, v179, s93
    v_perm_b32 v159, v191, v187, s93
    s_nop 1
    v_mov_b32_dpp v12, v16 row_shl:4 row_mask:0xf bank_mask:0xf
    v_mov_b32_dpp v13, v17 row_shl:4 row_mask:0xf bank_mask:0xf
    v_mov_b32_dpp v14, v18 row_shl:4 row_mask:0xf bank_mask:0xf
    v_mov_b32_dpp v15, v19 row_shl:4 row_mask:0xf bank_mask:0xf
    v_mfma_f32_16x16x32_bf16 v[96:99], v[16:19], v[192:195], 0
    v_mfma_f32_16x16x32_bf16 v[100:103], v[16:19], v[196:199], 0
    v_mfma_f32_16x16x32_bf16 v[104:107], v[16:19], v[200:203], 0
    v_mfma_f32_16x16x32_bf16 v[108:111], v[16:19], v[204:207], 0
    v_mfma_f32_16x16x32_bf16 v[112:115], v[16:19], v[208:211], 0
    v_mfma_f32_16x16x32_bf16 v[116:119], v[16:19], v[212:215], 0
    v_mfma_f32_16x16x32_bf16 v[120:123], v[16:19], v[216:219], 0
    v_mfma_f32_16x16x32_bf16 v[124:127], v[16:19], v[220:223], 0
    v_mfma_f32_16x16x32_bf16 v[96:99], v[12:15], v[128:131], v[96:99]
    v_mfma_f32_16x16x32_bf16 v[100:103], v[12:15], v[132:135], v[100:103]
    v_mfma_f32_16x16x32_bf16 v[104:107], v[12:15], v[136:139], v[104:107]
    v_mfma_f32_16x16x32_bf16 v[108:111], v[12:15], v[140:143], v[108:111]
    v_mfma_f32_16x16x32_bf16 v[112:115], v[12:15], v[144:147], v[112:115]
    v_mfma_f32_16x16x32_bf16 v[116:119], v[12:15], v[148:151], v[116:119]
    v_mfma_f32_16x16x32_bf16 v[120:123], v[12:15], v[152:155], v[120:123]
    v_mfma_f32_16x16x32_bf16 v[124:127], v[12:15], v[156:159], v[124:127]
    s_mov_b32 exec_lo, 0xff
    s_mov_b32 exec_hi, 0xff00
    ds_write_b128 v30, v[96:99] offset:0
    ds_write_b128 v30, v[100:103] offset:16
    ds_write_b128 v30, v[104:107] offset:32
    ds_write_b128 v30, v[108:111] offset:48
    ds_write_b128 v30, v[112:115] offset:64
    ds_write_b128 v30, v[116:119] offset:80
    ds_write_b128 v30, v[120:123] offset:96
    ds_write_b128 v30, v[124:127] offset:112
    s_mov_b64 exec, -1
    s_waitcnt lgkmcnt(0)
    s_mov_b32 s8, 1
    v_mov_b32 v34, s8
    s_lshl_b32 s9, s7, 2
    v_mov_b32 v35, s9
    s_mov_b64 exec, 1
    ds_write_b32 v35, v34 offset:0
    s_mov_b64 exec, -1
    v_mov_b32 v40, 0
    s_mov_b32 s13, 100000
L_lf_1:
    ds_read_b128 v[36:39], v40 offset:0
    s_waitcnt lgkmcnt(0)
    v_xor_b32 v36, s8, v36
    v_xor_b32 v37, s8, v37
    v_xor_b32 v38, s8, v38
    v_xor_b32 v39, s8, v39
    v_or3_b32 v36, v36, v37, v38
    v_or_b32 v36, v36, v39
    v_cmp_ne_u32 vcc, 0, v36
    s_cbranch_vccz L_lf_1_done
    s_sub_u32 s13, s13, 1
    s_cbranch_scc0 L_lf_1
L_lf_1_done:
    ds_read2st64_b32 v[40:41], v31 offset0:0 offset1:4
    ds_read2st64_b32 v[42:43], v31 offset0:8 offset1:12
    ds_read2st64_b32 v[44:45], v31 offset0:16 offset1:20
    ds_read2st64_b32 v[46:47], v31 offset0:24 offset1:28
    s_waitcnt lgkmcnt(2)
    v_add_f32 v40, v40, v41
    v_add_f32 v42, v42, v43
    v_add_f32 v40, v40, v42
    s_waitcnt lgkmcnt(0)
    v_add_f32 v44, v44, v45
    v_add_f32 v46, v46, v47
    v_add_f32 v44, v44, v46
    v_add_f32 v40, v40, v44
    s_nop 1
    v_mov_b32_dpp v44, v40 quad_perm:[0,0,0,0] row_mask:0xf bank_mask:0xf
    v_mov_b32_dpp v45, v40 quad_perm:[1,1,1,1] row_mask:0xf bank_mask:0xf
    v_mov_b32_dpp v46, v40 quad_perm:[2,2,2,2] row_mask:0xf bank_mask:0xf
    v_mov_b32_dpp v47, v40 quad_perm:[3,3,3,3] row_mask:0xf bank_mask:0xf
    v_cvt_pk_bf16_f32 v40, v44, v45
    v_mov_b32 v41, s12
    v_cvt_pk_bf16_f32 v42, v46, v47
    v_mov_b32 v43, s12
    s_mov_b32 exec_lo, 0x11111111
    s_mov_b32 exec_hi, 0x11111111
    buffer_store_dwordx4 v[40:43], v26, s[44:47], s97 offen sc1
    s_mov_b64 exec, -1
    s_waitcnt vmcnt(1)
    s_mov_b32 s8, 2
    v_mov_b32 v34, s8
    s_lshl_b32 s9, s7, 2
    v_mov_b32 v35, s9
    s_mov_b64 exec, 1
    ds_write_b32 v35, v34 offset:16
    s_mov_b64 exec, -1
    s_cmp_lg_u32 s7, 0
    s_cbranch_scc1 L_w0_2
    s_mov_b32 s8, 2
    v_mov_b32 v40, 0
    s_mov_b32 s13, 100000
L_lf_3:
    ds_read_b128 v[36:39], v40 offset:16
    s_waitcnt lgkmcnt(0)
    v_xor_b32 v36, s8, v36
    v_xor_b32 v37, s8, v37
    v_xor_b32 v38, s8, v38
    v_xor_b32 v39, s8, v39
    v_or3_b32 v36, v36, v37, v38
    v_or_b32 v36, v36, v39
    v_cmp_ne_u32 vcc, 0, v36
    s_cbranch_vccz L_lf_3_done
    s_sub_u32 s13, s13, 1
    s_cbranch_scc0 L_lf_3
L_lf_3_done:
    s_mov_b32 s68, s40
    s_mov_b32 s69, s41
    s_mov_b32 s70, 256
    s_mov_b32 s71, 0x20000
    v_mov_b32 v36, 1
    s_mov_b64 exec, 1
    buffer_atomic_add v36, v28, s[68:71], 0 offen sc1
    s_mov_b64 exec, -1
L_w0_2:
    s_branch L_plain
L_q:
    s_mov_b32 s52, s16
    s_mov_b32 s53, s17
    s_mov_b32 s54, 4096
    s_mov_b32 s55, 0x20000
    s_mov_b32 s56, s22
    s_mov_b32 s57, s23
    s_mov_b32 s58, 4194304
    s_mov_b32 s59, 0x20000
    s_lshl_b32 s8, s7, 7
    v_lshrrev_b32 v5, 3, v2
    v_lshlrev_b32 v5, 5, v5
    v_lshlrev_b32 v6, 3, v3
    v_add3_u32 v5, v5, v6, s8
    v_and_b32 v6, 7, v2
    v_lshlrev_b32 v6, 4, v6
    s_movk_i32 s9, 8192
    v_mul_lo_u32 v24, v5, s9
    v_add_u32 v24, v24, v6
    v_and_b32 v4, 4, v2
    v_lshlrev_b32 v4, 4, v4
    v_add_u32 v4, v4, v5
    s_sub_u32 s91, s3, 48
    s_lshr_b32 s91, s91, 3
    v_and_b32 v48, 3, v2
    v_lshlrev_b32 v49, 10, v48
    v_lshlrev_b32 v50, 1, v4
    v_add_u32 v50, v50, v49
    v_lshrrev_b32 v51, 2, v2
    v_lshlrev_b32 v52, 2, v3
    v_add_u32 v51, v51, v52
    v_lshlrev_b32 v51, 6, v51
    v_add_u32 v51, v51, v49
    s_lshl_b32 s99, s90, 10
    s_lshl_b32 s11, s91, 7
    s_add_u32 s99, s99, s11
    buffer_load_dwordx4 v[32:35], v51, s[52:55], 0 offen offset:0
    buffer_load_dwordx4 v[36:39], v51, s[52:55], 0 offen offset:16
    buffer_load_dwordx4 v[40:43], v51, s[52:55], 0 offen offset:32
    buffer_load_dwordx4 v[44:47], v51, s[52:55], 0 offen offset:48
    buffer_load_dwordx4 v[16:19], v50, s[52:55], 0 offen
    s_mov_b64 exec, s[100:101]
    buffer_store_dwordx4 v[8:11], v29, s[44:47], 0 offen sc1
    s_mov_b64 exec, -1
    buffer_load_dwordx4 v[128:131], v24, s[56:59], s99 offen offset:0 nt
    s_add_u32 s99, s99, 8192
    buffer_load_dwordx4 v[132:135], v24, s[56:59], s99 offen offset:0 nt
    s_add_u32 s99, s99, 8192
    buffer_load_dwordx4 v[136:139], v24, s[56:59], s99 offen offset:0 nt
    s_add_u32 s99, s99, 8192
    buffer_load_dwordx4 v[140:143], v24, s[56:59], s99 offen offset:0 nt
    s_add_u32 s99, s99, 8192
    buffer_load_dwordx4 v[144:147], v24, s[56:59], s99 offen offset:0 nt
    s_add_u32 s99, s99, 8192
    buffer_load_dwordx4 v[148:151], v24, s[56:59], s99 offen offset:0 nt
    s_add_u32 s99, s99, 8192
    buffer_load_dwordx4 v[152:155], v24, s[56:59], s99 offen offset:0 nt
    s_add_u32 s99, s99, 8192
    buffer_load_dwordx4 v[156:159], v24, s[56:59], s99 offen offset:0 nt
    s_add_u32 s99, s99, 466944
    buffer_load_dwordx4 v[160:163], v24, s[56:59], s99 offen offset:0 nt
    s_add_u32 s99, s99, 8192
    buffer_load_dwordx4 v[164:167], v24, s[56:59], s99 offen offset:0 nt
    s_add_u32 s99, s99, 8192
    buffer_load_dwordx4 v[168:171], v24, s[56:59], s99 offen offset:0 nt
    s_add_u32 s99, s99, 8192
    buffer_load_dwordx4 v[172:175], v24, s[56:59], s99 offen offset:0 nt
    s_add_u32 s99, s99, 8192
    buffer_load_dwordx4 v[176:179], v24, s[56:59], s99 offen offset:0 nt
    s_add_u32 s99, s99, 8192
    buffer_load_dwordx4 v[180:183], v24, s[56:59], s99 offen offset:0 nt
    s_add_u32 s99, s99, 8192
    buffer_load_dwordx4 v[184:187], v24, s[56:59], s99 offen offset:0 nt
    s_waitcnt vmcnt(14)
    s_lshl_b32 s8, s7, 11
    s_add_u32 s8, s8, 9728
    v_lshrrev_b32 v30, 1, v3
    v_lshlrev_b32 v30, 10, v30
    v_lshlrev_b32 v31, 3, v6
    v_add3_u32 v30, v30, v31, s8
    s_lshl_b32 s8, s7, 2
    s_add_u32 s8, s8, 9728
    v_add_u32 v31, s8, v25
    s_movk_i32 s9, 12288
    v_mul_lo_u32 v13, v48, s9
    v_lshlrev_b32 v12, 2, v4
    v_add_u32 v13, v13, v12
    s_waitcnt lgkmcnt(0)
    s_add_u32 s12, s12, 0x9E3779B9
    s_lshl_b32 s97, s7, 14
    s_lshl_b32 s11, s90, 11
    s_add_u32 s97, s97, s11
    s_lshl_b32 s11, s91, 8
    s_add_u32 s97, s97, s11
    s_add_u32 s97, s97, 65536
    s_mov_b32 s98, 4096
    v_lshlrev_b32 v48, 16, v32
    v_and_b32 v49, s14, v32
    v_lshlrev_b32 v50, 16, v33
    v_and_b32 v51, s14, v33
    v_lshlrev_b32 v52, 16, v34
    v_and_b32 v53, s14, v34
    v_lshlrev_b32 v54, 16, v35
    v_and_b32 v55, s14, v35
    v_lshlrev_b32 v56, 16, v36
    v_and_b32 v57, s14, v36
    v_lshlrev_b32 v58, 16, v37
    v_and_b32 v59, s14, v37
    v_lshlrev_b32 v60, 16, v38
    v_and_b32 v61, s14, v38
    v_lshlrev_b32 v62, 16, v39
    v_and_b32 v63, s14, v39
    v_lshlrev_b32 v64, 16, v40
    v_and_b32 v65, s14, v40
    v_lshlrev_b32 v66, 16, v41
    v_and_b32 v67, s14, v41
    v_lshlrev_b32 v68, 16, v42
    v_and_b32 v69, s14, v42
    v_lshlrev_b32 v70, 16, v43
    v_and_b32 v71, s14, v43
    v_lshlrev_b32 v72, 16, v44
    v_and_b32 v73, s14, v44
    v_lshlrev_b32 v74, 16, v45
    v_and_b32 v75, s14, v45
    v_lshlrev_b32 v76, 16, v46
    v_and_b32 v77, s14, v46
    v_lshlrev_b32 v78, 16, v47
    v_and_b32 v79, s14, v47
    v_add_f32 v32, v48, v49
    v_add_f32 v33, v50, v51
    v_add_f32 v34, v52, v53
    v_add_f32 v35, v54, v55
    v_add_f32 v36, v56, v57
    v_add_f32 v37, v58, v59
    v_add_f32 v38, v60, v61
    v_add_f32 v39, v62, v63
    v_add_f32 v40, v64, v65
    v_add_f32 v41, v66, v67
    v_add_f32 v42, v68, v69
    v_add_f32 v43, v70, v71
    v_add_f32 v44, v72, v73
    v_add_f32 v45, v74, v75
    v_add_f32 v46, v76, v77
    v_add_f32 v47, v78, v79
    v_add_f32 v32, v32, v40
    v_add_f32 v33, v33, v41
    v_add_f32 v34, v34, v42
    v_add_f32 v35, v35, v43
    v_add_f32 v36, v36, v44
    v_add_f32 v37, v37, v45
    v_add_f32 v38, v38, v46
    v_add_f32 v39, v39, v47
    v_add_f32 v32, v32, v36
    v_add_f32 v33, v33, v37
    v_add_f32 v34, v34, v38
    v_add_f32 v35, v35, v39
    v_add_f32 v32, v32, v34
    v_add_f32 v33, v33, v35
    v_add_f32 v32, v32, v33
    s_nop 1
    v_add_f32_dpp v32, v32, v32 row_ror:8 row_mask:0xf bank_mask:0xf
    s_nop 1
    v_add_f32_dpp v32, v32, v32 row_ror:4 row_mask:0xf bank_mask:0xf
    v_mov_b32 v33, v32
    s_nop 1
    v_permlane16_swap_b32 v32, v33
    v_add_f32 v32, v32, v33
    v_mov_b32 v33, v32
    s_nop 1
    v_permlane32_swap_b32 v32, v33
    v_add_f32 v32, v32, v33
    v_mul_f32 v32, 0x3b000000, v32
    v_sub_f32 v48, v48, v32
    v_sub_f32 v49, v49, v32
    v_sub_f32 v50, v50, v32
    v_sub_f32 v51, v51, v32
    v_sub_f32 v52, v52, v32
    v_sub_f32 v53, v53, v32
    v_sub_f32 v54, v54, v32
    v_sub_f32 v55, v55, v32
    v_sub_f32 v56, v56, v32
    v_sub_f32 v57, v57, v32
    v_sub_f32 v58, v58, v32
    v_sub_f32 v59, v59, v32
    v_sub_f32 v60, v60, v32
    v_sub_f32 v61, v61, v32
    v_sub_f32 v62, v62, v32
    v_sub_f32 v63, v63, v32
    v_sub_f32 v64, v64, v32
    v_sub_f32 v65, v65, v32
    v_sub_f32 v66, v66, v32
    v_sub_f32 v67, v67, v32
    v_sub_f32 v68, v68, v32
    v_sub_f32 v69, v69, v32
    v_sub_f32 v70, v70, v32
    v_sub_f32 v71, v71, v32
    v_sub_f32 v72, v72, v32
    v_sub_f32 v73, v73, v32
    v_sub_f32 v74, v74, v32
    v_sub_f32 v75, v75, v32
    v_sub_f32 v76, v76, v32
    v_sub_f32 v77, v77, v32
    v_sub_f32 v78, v78, v32
    v_sub_f32 v79, v79, v32
    v_mul_f32 v33, v48, v48
    v_mul_f32 v34, v49, v49
    v_fma_f32 v33, v50, v50, v33
    v_fma_f32 v34, v51, v51, v34
    v_fma_f32 v33, v52, v52, v33
    v_fma_f32 v34, v53, v53, v34
    v_fma_f32 v33, v54, v54, v33
    v_fma_f32 v34, v55, v55, v34
    v_fma_f32 v33, v56, v56, v33
    v_fma_f32 v34, v57, v57, v34
    v_fma_f32 v33, v58, v58, v33
    v_fma_f32 v34, v59, v59, v34
    v_fma_f32 v33, v60, v60, v33
    v_fma_f32 v34, v61, v61, v34
    v_fma_f32 v33, v62, v62, v33
    v_fma_f32 v34, v63, v63, v34
    v_fma_f32 v33, v64, v64, v33
    v_fma_f32 v34, v65, v65, v34
    v_fma_f32 v33, v66, v66, v33
    v_fma_f32 v34, v67, v67, v34
    v_fma_f32 v33, v68, v68, v33
    v_fma_f32 v34, v69, v69, v34
    v_fma_f32 v33, v70, v70, v33
    v_fma_f32 v34, v71, v71, v34
    v_fma_f32 v33, v72, v72, v33
    v_fma_f32 v34, v73, v73, v34
    v_fma_f32 v33, v74, v74, v33
    v_fma_f32 v34, v75, v75, v34
    v_fma_f32 v33, v76, v76, v33
    v_fma_f32 v34, v77, v77, v34
    v_fma_f32 v33, v78, v78, v33
    v_fma_f32 v34, v79, v79, v34
    v_add_f32 v33, v33, v34
    s_nop 1
    v_add_f32_dpp v33, v33, v33 row_ror:8 row_mask:0xf bank_mask:0xf
    s_nop 1
    v_add_f32_dpp v33, v33, v33 row_ror:4 row_mask:0xf bank_mask:0xf
    v_mov_b32 v34, v33
    s_nop 1
    v_permlane16_swap_b32 v33, v34
    v_add_f32 v33, v33, v34
    v_mov_b32 v34, v33
    s_nop 1
    v_permlane32_swap_b32 v33, v34
    v_add_f32 v33, v33, v34
    v_mul_f32 v33, 0x3b000000, v33
    v_cvt_pk_bf16_f32 v34, v32, v33
    v_lshlrev_b32 v32, 16, v34
    v_and_b32 v33, s14, v34
    v_add_f32 v33, 0x3727c5ac, v33
    v_cvt_pk_bf16_f32 v34, v33, v33
    v_lshlrev_b32 v33, 16, v34
    v_sqrt_f32 v33, v33
    s_nop 0
    v_cvt_pk_bf16_f32 v34, v33, v33
    v_lshlrev_b32 v33, 16, v34
    v_rcp_f32 v33, v33
    s_nop 0
    v_lshlrev_b32 v80, 16, v16
    v_and_b32 v81, s14, v16
    v_lshlrev_b32 v82, 16, v17
    v_and_b32 v83, s14, v17
    v_lshlrev_b32 v84, 16, v18
    v_and_b32 v85, s14, v18
    v_lshlrev_b32 v86, 16, v19
    v_and_b32 v87, s14, v19
    v_sub_f32 v80, v80, v32
    v_sub_f32 v81, v81, v32
    v_sub_f32 v82, v82, v32
    v_sub_f32 v83, v83, v32
    v_sub_f32 v84, v84, v32
    v_sub_f32 v85, v85, v32
    v_sub_f32 v86, v86, v32
    v_sub_f32 v87, v87, v32
    v_cvt_pk_bf16_f32 v34, v80, v81
    v_lshlrev_b32 v80, 16, v34
    v_and_b32 v81, s14, v34
    v_cvt_pk_bf16_f32 v34, v82, v83
    v_lshlrev_b32 v82, 16, v34
    v_and_b32 v83, s14, v34
    v_cvt_pk_bf16_f32 v34, v84, v85
    v_lshlrev_b32 v84, 16, v34
    v_and_b32 v85, s14, v34
    v_cvt_pk_bf16_f32 v34, v86, v87
    v_lshlrev_b32 v86, 16, v34
    v_and_b32 v87, s14, v34
    v_mul_f32 v80, v80, v33
    v_mul_f32 v81, v81, v33
    v_mul_f32 v82, v82, v33
    v_mul_f32 v83, v83, v33
    v_mul_f32 v84, v84, v33
    v_mul_f32 v85, v85, v33
    v_mul_f32 v86, v86, v33
    v_mul_f32 v87, v87, v33
    v_cvt_pk_bf16_f32 v34, v80, v81
    v_lshlrev_b32 v80, 16, v34
    v_and_b32 v81, s14, v34
    v_cvt_pk_bf16_f32 v34, v82, v83
    v_lshlrev_b32 v82, 16, v34
    v_and_b32 v83, s14, v34
    v_cvt_pk_bf16_f32 v34, v84, v85
    v_lshlrev_b32 v84, 16, v34
    v_and_b32 v85, s14, v34
    v_cvt_pk_bf16_f32 v34, v86, v87
    v_lshlrev_b32 v86, 16, v34
    v_and_b32 v87, s14, v34
    s_mov_b32 s8, 2
    v_mov_b32 v34, s8
    s_lshl_b32 s9, s7, 2
    v_mov_b32 v35, s9
    s_mov_b64 exec, 1
    ds_write_b32 v35, v34 offset:16
    s_mov_b64 exec, -1
    s_cmp_lg_u32 s7, 0
    s_cbranch_scc1 L_w0_4
    s_mov_b32 s8, 2
    v_mov_b32 v40, 0
    s_mov_b32 s13, 100000
L_lf_5:
    ds_read_b128 v[36:39], v40 offset:16
    s_waitcnt lgkmcnt(0)
    v_xor_b32 v36, s8, v36
    v_xor_b32 v37, s8, v37
    v_xor_b32 v38, s8, v38
    v_xor_b32 v39, s8, v39
    v_or3_b32 v36, v36, v37, v38
    v_or_b32 v36, v36, v39
    v_cmp_ne_u32 vcc, 0, v36
    s_cbranch_vccz L_lf_5_done
    s_sub_u32 s13, s13, 1
    s_cbranch_scc0 L_lf_5
L_lf_5_done:
    s_mov_b32 s68, s40
    s_mov_b32 s69, s41
    s_mov_b32 s70, 256
    s_mov_b32 s71, 0x20000
    v_mov_b32 v36, 1
    s_mov_b64 exec, 1
    buffer_atomic_add v36, v28, s[68:71], 0 offen sc1
    s_mov_b64 exec, -1
L_w0_4:
    s_add_u32 s99, s99, 8192
    buffer_load_dwordx4 v[188:191], v24, s[56:59], s99 offen offset:0 nt
    s_waitcnt vmcnt(8)
    v_perm_b32 v192, v132, v128, s92
    v_perm_b32 v193, v140, v136, s92
    v_perm_b32 v194, v148, v144, s92
    v_perm_b32 v195, v156, v152, s92
    v_perm_b32 v196, v132, v128, s93
    v_perm_b32 v197, v140, v136, s93
    v_perm_b32 v198, v148, v144, s93
    v_perm_b32 v199, v156, v152, s93
    v_perm_b32 v200, v133, v129, s92
    v_perm_b32 v201, v141, v137, s92
    v_perm_b32 v202, v149, v145, s92
    v_perm_b32 v203, v157, v153, s92
    v_perm_b32 v204, v133, v129, s93
    v_perm_b32 v205, v141, v137, s93
    v_perm_b32 v206, v149, v145, s93
    v_perm_b32 v207, v157, v153, s93
    v_perm_b32 v208, v134, v130, s92
    v_perm_b32 v209, v142, v138, s92
    v_perm_b32 v210, v150, v146, s92
    v_perm_b32 v211, v158, v154, s92
    v_perm_b32 v212, v134, v130, s93
    v_perm_b32 v213, v142, v138, s93
    v_perm_b32 v214, v150, v146, s93
    v_perm_b32 v215, v158, v154, s93
    v_perm_b32 v216, v135, v131, s92
    v_perm_b32 v217, v143, v139, s92
    v_perm_b32 v218, v151, v147, s92
    v_perm_b32 v219, v159, v155, s92
    v_perm_b32 v220, v135, v131, s93
    v_perm_b32 v221, v143, v139, s93
    v_perm_b32 v222, v151, v147, s93
    v_perm_b32 v223, v159, v155, s93
    s_waitcnt vmcnt(0)
    v_perm_b32 v128, v164, v160, s92
    v_perm_b32 v129, v172, v168, s92
    v_perm_b32 v130, v180, v176, s92
    v_perm_b32 v131, v188, v184, s92
    v_perm_b32 v132, v164, v160, s93
    v_perm_b32 v133, v172, v168, s93
    v_perm_b32 v134, v180, v176, s93
    v_perm_b32 v135, v188, v184, s93
    v_perm_b32 v136, v165, v161, s92
    v_perm_b32 v137, v173, v169, s92
    v_perm_b32 v138, v181, v177, s92
    v_perm_b32 v139, v189, v185, s92
    v_perm_b32 v140, v165, v161, s93
    v_perm_b32 v141, v173, v169, s93
    v_perm_b32 v142, v181, v177, s93
    v_perm_b32 v143, v189, v185, s93
    v_perm_b32 v144, v166, v162, s92
    v_perm_b32 v145, v174, v170, s92
    v_perm_b32 v146, v182, v178, s92
    v_perm_b32 v147, v190, v186, s92
    v_perm_b32 v148, v166, v162, s93
    v_perm_b32 v149, v174, v170, s93
    v_perm_b32 v150, v182, v178, s93
    v_perm_b32 v151, v190, v186, s93
    v_perm_b32 v152, v167, v163, s92
    v_perm_b32 v153, v175, v171, s92
    v_perm_b32 v154, v183, v179, s92
    v_perm_b32 v155, v191, v187, s92
    v_perm_b32 v156, v167, v163, s93
    v_perm_b32 v157, v175, v171, s93
    v_perm_b32 v158, v183, v179, s93
    v_perm_b32 v159, v191, v187, s93
    s_mov_b32 s13, 100000
L_pm_6:
    buffer_load_dwordx4 v[48:51], v13, s[44:47], s98 offen offset:0 sc1
    buffer_load_dwordx4 v[52:55], v13, s[44:47], s98 offen offset:16 sc1
    buffer_load_dwordx4 v[56:59], v13, s[44:47], s98 offen offset:2048 sc1
    buffer_load_dwordx4 v[60:63], v13, s[44:47], s98 offen offset:2064 sc1
    s_waitcnt vmcnt(0)
    v_xor_b32 v49, s12, v49
    v_xor_b32 v51, s12, v51
    v_xor_b32 v53, s12, v53
    v_xor_b32 v55, s12, v55
    v_xor_b32 v57, s12, v57
    v_xor_b32 v59, s12, v59
    v_xor_b32 v61, s12, v61
    v_xor_b32 v63, s12, v63
    v_or3_b32 v49, v49, v51, v53
    v_or3_b32 v55, v55, v57, v59
    v_or3_b32 v49, v49, v61, v63
    v_or_b32 v49, v49, v55
    v_cmp_ne_u32 vcc, 0, v49
    s_cbranch_vccz L_pm_6_done
    s_sleep 16
    s_sub_u32 s13, s13, 1
    s_cbranch_scc0 L_pm_6
L_pm_6_done:
    v_lshlrev_b32 v64, 16, v56
    v_and_b32 v65, s14, v56
    v_lshlrev_b32 v66, 16, v58
    v_and_b32 v67, s14, v58
    v_lshlrev_b32 v68, 16, v60
    v_and_b32 v69, s14, v60
    v_lshlrev_b32 v70, 16, v62
    v_and_b32 v71, s14, v62
    v_lshlrev_b32 v72, 16, v48
    v_and_b32 v73, s14, v48
    v_lshlrev_b32 v74, 16, v50
    v_and_b32 v75, s14, v50
    v_lshlrev_b32 v76, 16, v52
    v_and_b32 v77, s14, v52
    v_lshlrev_b32 v78, 16, v54
    v_and_b32 v79, s14, v54
    v_add_f32 v64, 1.0, v64
    v_add_f32 v65, 1.0, v65
    v_add_f32 v66, 1.0, v66
    v_add_f32 v67, 1.0, v67
    v_add_f32 v68, 1.0, v68
    v_add_f32 v69, 1.0, v69
    v_add_f32 v70, 1.0, v70
    v_add_f32 v71, 1.0, v71
    v_cvt_pk_bf16_f32 v34, v64, v65
    v_lshlrev_b32 v64, 16, v34
    v_and_b32 v65, s14, v34
    v_cvt_pk_bf16_f32 v34, v66, v67
    v_lshlrev_b32 v66, 16, v34
    v_and_b32 v67, s14, v34
    v_cvt_pk_bf16_f32 v34, v68, v69
    v_lshlrev_b32 v68, 16, v34
    v_and_b32 v69, s14, v34
    v_cvt_pk_bf16_f32 v34, v70, v71
    v_lshlrev_b32 v70, 16, v34
    v_and_b32 v71, s14, v34
    v_mul_f32 v64, v64, v80
    v_mul_f32 v65, v65, v81
    v_mul_f32 v66, v66, v82
    v_mul_f32 v67, v67, v83
    v_mul_f32 v68, v68, v84
    v_mul_f32 v69, v69, v85
    v_mul_f32 v70, v70, v86
    v_mul_f32 v71, v71, v87
    v_cvt_pk_bf16_f32 v34, v64, v65
    v_lshlrev_b32 v64, 16, v34
    v_and_b32 v65, s14, v34
    v_cvt_pk_bf16_f32 v34, v66, v67
    v_lshlrev_b32 v66, 16, v34
    v_and_b32 v67, s14, v34
    v_cvt_pk_bf16_f32 v34, v68, v69
    v_lshlrev_b32 v68, 16, v34
    v_and_b32 v69, s14, v34
    v_cvt_pk_bf16_f32 v34, v70, v71
    v_lshlrev_b32 v70, 16, v34
    v_and_b32 v71, s14, v34
    v_add_f32 v64, v64, v72
    v_add_f32 v65, v65, v73
    v_add_f32 v66, v66, v74
    v_add_f32 v67, v67, v75
    v_add_f32 v68, v68, v76
    v_add_f32 v69, v69, v77
    v_add_f32 v70, v70, v78
    v_add_f32 v71, v71, v79
    v_cvt_pk_bf16_f32 v16, v64, v65
    v_cvt_pk_bf16_f32 v17, v66, v67
    v_cvt_pk_bf16_f32 v18, v68, v69
    v_cvt_pk_bf16_f32 v19, v70, v71
    s_nop 1
    v_mov_b32_dpp v12, v16 row_shl:4 row_mask:0xf bank_mask:0xf
    v_mov_b32_dpp v13, v17 row_shl:4 row_mask:0xf bank_mask:0xf
    v_mov_b32_dpp v14, v18 row_shl:4 row_mask:0xf bank_mask:0xf
    v_mov_b32_dpp v15, v19 row_shl:4 row_mask:0xf bank_mask:0xf
    v_mfma_f32_16x16x32_bf16 v[96:99], v[16:19], v[192:195], 0
    v_mfma_f32_16x16x32_bf16 v[100:103], v[16:19], v[196:199], 0
    v_mfma_f32_16x16x32_bf16 v[104:107], v[16:19], v[200:203], 0
    v_mfma_f32_16x16x32_bf16 v[108:111], v[16:19], v[204:207], 0
    v_mfma_f32_16x16x32_bf16 v[112:115], v[16:19], v[208:211], 0
    v_mfma_f32_16x16x32_bf16 v[116:119], v[16:19], v[212:215], 0
    v_mfma_f32_16x16x32_bf16 v[120:123], v[16:19], v[216:219], 0
    v_mfma_f32_16x16x32_bf16 v[124:127], v[16:19], v[220:223], 0
    v_mfma_f32_16x16x32_bf16 v[96:99], v[12:15], v[128:131], v[96:99]
    v_mfma_f32_16x16x32_bf16 v[100:103], v[12:15], v[132:135], v[100:103]
    v_mfma_f32_16x16x32_bf16 v[104:107], v[12:15], v[136:139], v[104:107]
    v_mfma_f32_16x16x32_bf16 v[108:111], v[12:15], v[140:143], v[108:111]
    v_mfma_f32_16x16x32_bf16 v[112:115], v[12:15], v[144:147], v[112:115]
    v_mfma_f32_16x16x32_bf16 v[116:119], v[12:15], v[148:151], v[116:119]
    v_mfma_f32_16x16x32_bf16 v[120:123], v[12:15], v[152:155], v[120:123]
    v_mfma_f32_16x16x32_bf16 v[124:127], v[12:15], v[156:159], v[124:127]
    s_mov_b32 exec_lo, 0xff
    s_mov_b32 exec_hi, 0xff00
    ds_write_b128 v30, v[96:99] offset:0
    ds_write_b128 v30, v[100:103] offset:16
    ds_write_b128 v30, v[104:107] offset:32
    ds_write_b128 v30, v[108:111] offset:48
    ds_write_b128 v30, v[112:115] offset:64
    ds_write_b128 v30, v[116:119] offset:80
    ds_write_b128 v30, v[120:123] offset:96
    ds_write_b128 v30, v[124:127] offset:112
    s_mov_b64 exec, -1
    s_waitcnt lgkmcnt(0)
    s_mov_b32 s8, 1
    v_mov_b32 v34, s8
    s_lshl_b32 s9, s7, 2
    v_mov_b32 v35, s9
    s_mov_b64 exec, 1
    ds_write_b32 v35, v34 offset:0
    s_mov_b64 exec, -1
    v_mov_b32 v40, 0
    s_mov_b32 s13, 100000
L_lf_7:
    ds_read_b128 v[36:39], v40 offset:0
    s_waitcnt lgkmcnt(0)
    v_xor_b32 v36, s8, v36
    v_xor_b32 v37, s8, v37
    v_xor_b32 v38, s8, v38
    v_xor_b32 v39, s8, v39
    v_or3_b32 v36, v36, v37, v38
    v_or_b32 v36, v36, v39
    v_cmp_ne_u32 vcc, 0, v36
    s_cbranch_vccz L_lf_7_done
    s_sub_u32 s13, s13, 1
    s_cbranch_scc0 L_lf_7
L_lf_7_done:
    ds_read2st64_b32 v[40:41], v31 offset0:0 offset1:4
    ds_read2st64_b32 v[42:43], v31 offset0:8 offset1:12
    ds_read2st64_b32 v[44:45], v31 offset0:16 offset1:20
    ds_read2st64_b32 v[46:47], v31 offset0:24 offset1:28
    s_waitcnt lgkmcnt(2)
    v_add_f32 v40, v40, v41
    v_add_f32 v42, v42, v43
    v_add_f32 v40, v40, v42
    s_waitcnt lgkmcnt(0)
    v_add_f32 v44, v44, v45
    v_add_f32 v46, v46, v47
    v_add_f32 v44, v44, v46
    v_add_f32 v40, v40, v44
    s_nop 1
    v_mov_b32_dpp v44, v40 quad_perm:[0,0,0,0] row_mask:0xf bank_mask:0xf
    v_mov_b32_dpp v45, v40 quad_perm:[1,1,1,1] row_mask:0xf bank_mask:0xf
    v_mov_b32_dpp v46, v40 quad_perm:[2,2,2,2] row_mask:0xf bank_mask:0xf
    v_mov_b32_dpp v47, v40 quad_perm:[3,3,3,3] row_mask:0xf bank_mask:0xf
    v_cvt_pk_bf16_f32 v40, v44, v45
    v_mov_b32 v41, s12
    v_cvt_pk_bf16_f32 v42, v46, v47
    v_mov_b32 v43, s12
    s_mov_b32 exec_lo, 0x11111111
    s_mov_b32 exec_hi, 0x11111111
    buffer_store_dwordx4 v[40:43], v26, s[44:47], s97 offen sc1
    s_mov_b64 exec, -1
    s_lshl_b32 s96, s95, 11
    s_add_u32 s96, s96, 65536
    s_lshl_b32 s8, s7, 9
    s_add_u32 s96, s96, s8
    s_lshl_b32 s8, s7, 8
    s_add_u32 s8, s8, 256
    v_add_u32 v33, s8, v26
    s_mov_b32 s13, 100000
L_pq_8:
    buffer_load_dwordx2 v[40:41], v27, s[44:47], s96 offen sc1
    s_waitcnt vmcnt(0)
    v_cmp_ne_u32 vcc, s12, v41
    s_cbranch_vccz L_pq_8_done
    s_sleep 16
    s_sub_u32 s13, s13, 1
    s_cbranch_scc0 L_pq_8
L_pq_8_done:
    ds_write_b32 v33, v40
    s_waitcnt lgkmcnt(0)
    s_mov_b32 s8, 3
    v_mov_b32 v34, s8
    s_lshl_b32 s9, s7, 2
    v_mov_b32 v35, s9
    s_mov_b64 exec, 1
    ds_write_b32 v35, v34 offset:32
    s_mov_b64 exec, -1
    s_cmp_eq_u32 s7, 0
    s_cbranch_scc1 L_stay_9
    s_endpgm
L_stay_9:
    s_sub_u32 s91, s3, 48
    s_lshr_b32 s90, s91, 4
    s_lshl_b32 s97, s91, 13
    s_add_u32 s97, s97, 524288
    s_add_u32 s99, s97, 4096
    s_lshl_b32 s98, s91, 6
    s_and_b32 s91, s91, 15
    s_lshl_b32 s91, s91, 7
    s_mov_b32 s48, s16
    s_mov_b32 s49, s17
    s_mov_b32 s50, 4096
    s_mov_b32 s51, 0x20000
    s_mul_i32 s9, s90, 12288
    s_add_u32 s9, s9, s91
    s_add_u32 s9, s9, 8192
    s_add_u32 s10, s9, 6144
    s_lshl_b32 s96, s90, 14
    s_add_u32 s96, s96, s91
    s_lshr_b32 s96, s96, 1
    s_add_u32 s96, s96, 458752
    v_and_b32 v36, 7, v0
    v_lshlrev_b32 v37, 3, v36
    v_lshlrev_b32 v38, 4, v36
    buffer_load_dwordx2 v[8:9], v37, s[48:51], s98 offen
    v_lshrrev_b32 v39, 3, v0
    v_lshlrev_b32 v39, 10, v39
    v_add_u32 v39, v39, v37
    s_mov_b32 s13, 100000
L_pc_10:
    buffer_load_dwordx4 v[40:43], v38, s[44:47], s9 offen sc1
    buffer_load_dwordx4 v[44:47], v38, s[44:47], s10 offen sc1
    s_waitcnt vmcnt(0)
    v_xor_b32 v41, s12, v41
    v_xor_b32 v43, s12, v43
    v_xor_b32 v45, s12, v45
    v_xor_b32 v47, s12, v47
    v_or3_b32 v41, v41, v43, v45
    v_or_b32 v41, v41, v47
    v_cmp_ne_u32 vcc, 0, v41
    s_cbranch_vccz L_pc_10_done
    s_sleep 16
    s_sub_u32 s13, s13, 1
    s_cbranch_scc0 L_pc_10
L_pc_10_done:
    v_lshlrev_b32 v12, 16, v8
    v_and_b32 v13, s14, v8
    v_lshlrev_b32 v14, 16, v9
    v_and_b32 v15, s14, v9
    v_lshlrev_b32 v16, 16, v40
    v_and_b32 v17, s14, v40
    v_lshlrev_b32 v18, 16, v42
    v_and_b32 v19, s14, v42
    v_lshlrev_b32 v20, 16, v44
    v_and_b32 v21, s14, v44
    v_lshlrev_b32 v22, 16, v46
    v_and_b32 v23, s14, v46
    s_mov_b32 s48, s38
    s_mov_b32 s49, s39
    s_mov_b32 s50, 4096
    s_mov_b32 s51, 0x20000
    s_mov_b32 s68, s40
    s_mov_b32 s69, s41
    s_mov_b32 s70, 256
    s_mov_b32 s71, 0x20000
    s_mov_b32 s13, 100000
L_pa_11:
    buffer_load_dword v40, v28, s[68:71], 0 offen sc1
    s_waitcnt vmcnt(0)
    v_cmp_gt_u32 vcc, 0x100, v40
    s_cbranch_vccz L_pa_11_done
    s_sleep 16
    s_sub_u32 s13, s13, 1
    s_cbranch_scc0 L_pa_11
L_pa_11_done:
    s_cmp_lg_u32 s2, 0
    s_cbranch_scc1 L_noep_12
    v_mov_b32 v40, s12
    s_mov_b64 exec, 1
    buffer_store_dword v40, v28, s[44:47], 0 offen offset:0 sc1
    s_mov_b64 exec, -1
L_noep_12:
    s_barrier
    s_mov_b32 s13, 100000
L_f2_13:
    buffer_load_dwordx2 v[46:47], v39, s[44:47], s96 offen sc1
    s_waitcnt vmcnt(0)
    v_max_u32 v44, v46, v47
    v_cmp_eq_u32 vcc, -1, v44
    s_cbranch_vccz L_f2_13_done
    s_sub_u32 s13, s13, 1
    s_cbranch_scc0 L_f2_13
L_f2_13_done:
    v_lshlrev_b32 v40, 16, v46
    v_and_b32 v41, s14, v46
    v_lshlrev_b32 v42, 16, v47
    v_and_b32 v43, s14, v47
    s_mov_b64 s[52:53], -1
    s_mov_b64 s[54:55], -1
    s_mov_b64 s[56:57], -1
    s_mov_b64 s[58:59], -1
    s_mov_b64 s[60:61], -1
    s_mov_b64 s[62:63], -1
    s_mov_b64 s[64:65], -1
    buffer_load_dwordx4 v[64:67], v25, s[44:47], s97 offen offset:0 sc1
    buffer_load_dwordx4 v[68:71], v25, s[44:47], s97 offen offset:1024 sc1
    buffer_load_dwordx4 v[72:75], v25, s[44:47], s97 offen offset:2048 sc1
    buffer_load_dwordx4 v[76:79], v25, s[44:47], s97 offen offset:3072 sc1
    buffer_load_dwordx4 v[80:83], v25, s[44:47], s99 offen offset:0 sc1
    buffer_load_dwordx4 v[84:87], v25, s[44:47], s99 offen offset:1024 sc1
    buffer_load_dwordx4 v[88:91], v25, s[44:47], s99 offen offset:2048 sc1
    s_nop 1
    v_add_f32_dpp v40, v40, v40 row_ror:8 row_mask:0xf bank_mask:0xf
    v_add_f32_dpp v41, v41, v41 row_ror:8 row_mask:0xf bank_mask:0xf
    v_add_f32_dpp v42, v42, v42 row_ror:8 row_mask:0xf bank_mask:0xf
    v_add_f32_dpp v43, v43, v43 row_ror:8 row_mask:0xf bank_mask:0xf
    v_mov_b32 v44, v40
    v_mov_b32 v45, v41
    v_mov_b32 v46, v42
    v_mov_b32 v47, v43
    v_permlane16_swap_b32 v40, v44
    v_permlane16_swap_b32 v41, v45
    v_permlane16_swap_b32 v42, v46
    v_permlane16_swap_b32 v43, v47
    v_add_f32 v40, v40, v44
    v_add_f32 v41, v41, v45
    v_add_f32 v42, v42, v46
    v_add_f32 v43, v43, v47
    v_mov_b32 v44, v40
    v_mov_b32 v45, v41
    v_mov_b32 v46, v42
    v_mov_b32 v47, v43
    v_permlane32_swap_b32 v40, v44
    v_permlane32_swap_b32 v41, v45
    v_permlane32_swap_b32 v42, v46
    v_permlane32_swap_b32 v43, v47
    v_add_f32 v40, v40, v44
    v_add_f32 v41, v41, v45
    v_add_f32 v42, v42, v46
    v_add_f32 v43, v43, v47
    v_cvt_pk_bf16_f32 v44, v40, v41
    v_lshlrev_b32 v40, 16, v44
    v_and_b32 v41, s14, v44
    v_cvt_pk_bf16_f32 v44, v42, v43
    v_lshlrev_b32 v42, 16, v44
    v_and_b32 v43, s14, v44
    v_mul_f32 v40, v40, v16
    v_mul_f32 v41, v41, v17
    v_mul_f32 v42, v42, v18
    v_mul_f32 v43, v43, v19
    v_cvt_pk_bf16_f32 v44, v40, v41
    v_lshlrev_b32 v40, 16, v44
    v_and_b32 v41, s14, v44
    v_cvt_pk_bf16_f32 v44, v42, v43
    v_lshlrev_b32 v42, 16, v44
    v_and_b32 v43, s14, v44
    v_add_f32 v12, v40, v12
    v_add_f32 v13, v41, v13
    v_add_f32 v14, v42, v14
    v_add_f32 v15, v43, v15
    v_cvt_pk_bf16_f32 v44, v12, v13
    v_lshlrev_b32 v12, 16, v44
    v_and_b32 v13, s14, v44
    v_cvt_pk_bf16_f32 v44, v14, v15
    v_lshlrev_b32 v14, 16, v44
    v_and_b32 v15, s14, v44
    s_mov_b32 s13, 100000
    s_branch L_f3w
L_f3_14:
    s_mov_b64 exec, s[52:53]
    s_cbranch_execz L_ml_15
    buffer_load_dwordx4 v[64:67], v25, s[44:47], s97 offen offset:0 sc1
L_ml_15:
    s_mov_b64 exec, s[54:55]
    s_cbranch_execz L_ml_16
    buffer_load_dwordx4 v[68:71], v25, s[44:47], s97 offen offset:1024 sc1
L_ml_16:
    s_mov_b64 exec, s[56:57]
    s_cbranch_execz L_ml_17
    buffer_load_dwordx4 v[72:75], v25, s[44:47], s97 offen offset:2048 sc1
L_ml_17:
    s_mov_b64 exec, s[58:59]
    s_cbranch_execz L_ml_18
    buffer_load_dwordx4 v[76:79], v25, s[44:47], s97 offen offset:3072 sc1
L_ml_18:
    s_mov_b64 exec, s[60:61]
    s_cbranch_execz L_ml_19
    buffer_load_dwordx4 v[80:83], v25, s[44:47], s99 offen offset:0 sc1
L_ml_19:
    s_mov_b64 exec, s[62:63]
    s_cbranch_execz L_ml_20
    buffer_load_dwordx4 v[84:87], v25, s[44:47], s99 offen offset:1024 sc1
L_ml_20:
    s_mov_b64 exec, s[64:65]
    s_cbranch_execz L_ml_21
    buffer_load_dwordx4 v[88:91], v25, s[44:47], s99 offen offset:2048 sc1
L_ml_21:
    s_mov_b64 exec, -1
L_f3w:
    s_waitcnt vmcnt(0)
    v_add_f32 v40, v64, v68
    v_add_f32 v41, v65, v69
    v_add_f32 v42, v66, v70
    v_add_f32 v43, v67, v71
    v_add_f32 v44, v72, v76
    v_add_f32 v45, v73, v77
    v_add_f32 v46, v74, v78
    v_add_f32 v47, v75, v79
    v_add_f32 v48, v80, v84
    v_add_f32 v49, v81, v85
    v_add_f32 v50, v82, v86
    v_add_f32 v51, v83, v87
    v_add_f32 v40, v40, v88
    v_add_f32 v41, v41, v89
    v_add_f32 v42, v42, v90
    v_add_f32 v43, v43, v91
    v_add_f32 v44, v44, v48
    v_add_f32 v45, v45, v49
    v_add_f32 v46, v46, v50
    v_add_f32 v47, v47, v51
    v_add_f32 v40, v40, v44
    v_add_f32 v41, v41, v45
    v_add_f32 v42, v42, v46
    v_add_f32 v43, v43, v47
    s_nop 1
    v_add_f32_dpp v40, v40, v40 row_ror:8 row_mask:0xf bank_mask:0xf
    v_add_f32_dpp v41, v41, v41 row_ror:8 row_mask:0xf bank_mask:0xf
    v_add_f32_dpp v42, v42, v42 row_ror:8 row_mask:0xf bank_mask:0xf
    v_add_f32_dpp v43, v43, v43 row_ror:8 row_mask:0xf bank_mask:0xf
    v_mov_b32 v44, v40
    v_mov_b32 v45, v41
    v_mov_b32 v46, v42
    v_mov_b32 v47, v43
    v_permlane16_swap_b32 v40, v44
    v_permlane16_swap_b32 v41, v45
    v_permlane16_swap_b32 v42, v46
    v_permlane16_swap_b32 v43, v47
    v_add_f32 v40, v40, v44
    v_add_f32 v41, v41, v45
    v_add_f32 v42, v42, v46
    v_add_f32 v43, v43, v47
    v_mov_b32 v44, v40
    v_mov_b32 v45, v41
    v_mov_b32 v46, v42
    v_mov_b32 v47, v43
    v_permlane32_swap_b32 v40, v44
    v_permlane32_swap_b32 v41, v45
    v_permlane32_swap_b32 v42, v46
    v_permlane32_swap_b32 v43, v47
    v_add_f32 v40, v40, v44
    v_add_f32 v41, v41, v45
    v_add_f32 v42, v42, v46
    v_add_f32 v43, v43, v47
    v_cmp_u_f32 vcc, v40, v41
    v_cmp_u_f32 s[100:101], v42, v43
    s_or_b64 vcc, vcc, s[100:101]
    s_cbranch_scc0 L_f3_14_done
    v_max3_u32 v44, v64, v65, v66
    v_max_u32 v44, v44, v67
    v_cmp_eq_u32 s[52:53], -1, v44
    v_max3_u32 v45, v68, v69, v70
    v_max_u32 v45, v45, v71
    v_cmp_eq_u32 s[54:55], -1, v45
    v_max3_u32 v44, v72, v73, v74
    v_max_u32 v44, v44, v75
    v_cmp_eq_u32 s[56:57], -1, v44
    v_max3_u32 v45, v76, v77, v78
    v_max_u32 v45, v45, v79
    v_cmp_eq_u32 s[58:59], -1, v45
    v_max3_u32 v44, v80, v81, v82
    v_max_u32 v44, v44, v83
    v_cmp_eq_u32 s[60:61], -1, v44
    v_max3_u32 v45, v84, v85, v86
    v_max_u32 v45, v45, v87
    v_cmp_eq_u32 s[62:63], -1, v45
    v_max3_u32 v44, v88, v89, v90
    v_max_u32 v44, v44, v91
    v_cmp_eq_u32 s[64:65], -1, v44
    s_or_b64 s[100:101], s[52:53], s[54:55]
    s_or_b64 s[100:101], s[100:101], s[56:57]
    s_or_b64 s[100:101], s[100:101], s[58:59]
    s_or_b64 s[100:101], s[100:101], s[60:61]
    s_or_b64 s[100:101], s[100:101], s[62:63]
    s_or_b64 s[100:101], s[100:101], s[64:65]
    s_cbranch_scc0 L_f3_14_done
    s_sub_u32 s13, s13, 1
    s_cbranch_scc0 L_f3_14
L_f3_14_done:
    v_cvt_pk_bf16_f32 v44, v40, v41
    v_lshlrev_b32 v40, 16, v44
    v_and_b32 v41, s14, v44
    v_cvt_pk_bf16_f32 v44, v42, v43
    v_lshlrev_b32 v42, 16, v44
    v_and_b32 v43, s14, v44
    v_mul_f32 v40, v40, v20
    v_mul_f32 v41, v41, v21
    v_mul_f32 v42, v42, v22
    v_mul_f32 v43, v43, v23
    v_cvt_pk_bf16_f32 v44, v40, v41
    v_lshlrev_b32 v40, 16, v44
    v_and_b32 v41, s14, v44
    v_cvt_pk_bf16_f32 v44, v42, v43
    v_lshlrev_b32 v42, 16, v44
    v_and_b32 v43, s14, v44
    v_add_f32 v40, v40, v12
    v_add_f32 v41, v41, v13
    v_add_f32 v42, v42, v14
    v_add_f32 v43, v43, v15
    v_cvt_pk_bf16_f32 v44, v40, v41
    v_cvt_pk_bf16_f32 v45, v42, v43
    s_mov_b64 exec, 0xff
    buffer_store_dwordx2 v[44:45], v37, s[48:51], s98 offen
    s_endpgm
L_none:
    s_mov_b64 exec, s[100:101]
    buffer_store_dwordx4 v[8:11], v29, s[44:47], 0 offen sc1
    s_mov_b64 exec, -1
    s_waitcnt lgkmcnt(0)
    s_add_u32 s12, s12, 0x9E3779B9
    s_waitcnt vmcnt(0)
    s_mov_b32 s8, 2
    v_mov_b32 v34, s8
    s_lshl_b32 s9, s7, 2
    v_mov_b32 v35, s9
    s_mov_b64 exec, 1
    ds_write_b32 v35, v34 offset:16
    s_mov_b64 exec, -1
    s_cmp_lg_u32 s7, 0
    s_cbranch_scc1 L_w0_22
    s_mov_b32 s8, 2
    v_mov_b32 v40, 0
    s_mov_b32 s13, 100000
L_lf_23:
    ds_read_b128 v[36:39], v40 offset:16
    s_waitcnt lgkmcnt(0)
    v_xor_b32 v36, s8, v36
    v_xor_b32 v37, s8, v37
    v_xor_b32 v38, s8, v38
    v_xor_b32 v39, s8, v39
    v_or3_b32 v36, v36, v37, v38
    v_or_b32 v36, v36, v39
    v_cmp_ne_u32 vcc, 0, v36
    s_cbranch_vccz L_lf_23_done
    s_sub_u32 s13, s13, 1
    s_cbranch_scc0 L_lf_23
L_lf_23_done:
    s_mov_b32 s68, s40
    s_mov_b32 s69, s41
    s_mov_b32 s70, 256
    s_mov_b32 s71, 0x20000
    v_mov_b32 v36, 1
    s_mov_b64 exec, 1
    buffer_atomic_add v36, v28, s[68:71], 0 offen sc1
    s_mov_b64 exec, -1
L_w0_22:
L_plain:
    s_lshl_b32 s96, s95, 11
    s_add_u32 s96, s96, 65536
    s_lshl_b32 s8, s7, 9
    s_add_u32 s96, s96, s8
    s_lshl_b32 s8, s7, 8
    s_add_u32 s8, s8, 256
    v_add_u32 v33, s8, v26
    s_mov_b32 s13, 100000
L_pq_24:
    buffer_load_dwordx2 v[40:41], v27, s[44:47], s96 offen sc1
    s_waitcnt vmcnt(0)
    v_cmp_ne_u32 vcc, s12, v41
    s_cbranch_vccz L_pq_24_done
    s_sleep 16
    s_sub_u32 s13, s13, 1
    s_cbranch_scc0 L_pq_24
L_pq_24_done:
    ds_write_b32 v33, v40
    s_waitcnt lgkmcnt(0)
    s_mov_b32 s8, 3
    v_mov_b32 v34, s8
    s_lshl_b32 s9, s7, 2
    v_mov_b32 v35, s9
    s_mov_b64 exec, 1
    ds_write_b32 v35, v34 offset:32
    s_mov_b64 exec, -1
    s_cmp_eq_u32 s7, 0
    s_cbranch_scc1 L_stay_25
    s_endpgm
L_stay_25:
    s_mov_b32 s68, s40
    s_mov_b32 s69, s41
    s_mov_b32 s70, 256
    s_mov_b32 s71, 0x20000
    s_mov_b32 s13, 100000
L_pa_26:
    buffer_load_dword v40, v28, s[68:71], 0 offen sc1
    s_waitcnt vmcnt(0)
    v_cmp_gt_u32 vcc, 0x100, v40
    s_cbranch_vccz L_pa_26_done
    s_sleep 16
    s_sub_u32 s13, s13, 1
    s_cbranch_scc0 L_pa_26
L_pa_26_done:
    s_cmp_lg_u32 s2, 0
    s_cbranch_scc1 L_noep_27
    v_mov_b32 v40, s12
    s_mov_b64 exec, 1
    buffer_store_dword v40, v28, s[44:47], 0 offen offset:0 sc1
    s_mov_b64 exec, -1
L_noep_27:
    s_endpgm
L_wo:
    s_mov_b32 s56, s24
    s_mov_b32 s57, s25
    s_mov_b32 s58, 4194304
    s_mov_b32 s59, 0x20000
    s_lshl_b32 s8, s7, 7
    v_lshrrev_b32 v5, 3, v2
    v_lshlrev_b32 v5, 5, v5
    v_lshlrev_b32 v6, 3, v3
    v_add3_u32 v5, v5, v6, s8
    v_and_b32 v6, 7, v2
    v_lshlrev_b32 v6, 4, v6
    s_movk_i32 s9, 1024
    v_mul_lo_u32 v24, v5, s9
    v_add_u32 v24, v24, v6
    v_and_b32 v4, 4, v2
    v_lshlrev_b32 v4, 4, v4
    v_add_u32 v4, v4, v5
    s_sub_u32 s91, s3, 112
    s_lshr_b32 s91, s91, 3
    s_lshl_b32 s99, s90, 19
    s_lshl_b32 s11, s91, 7
    s_add_u32 s99, s99, s11
    s_mov_b64 exec, s[100:101]
    buffer_store_dwordx4 v[8:11], v29, s[44:47], 0 offen sc1
    s_mov_b64 exec, -1
    buffer_load_dwordx4 v[128:131], v24, s[56:59], s99 offen offset:0 nt
    buffer_load_dwordx4 v[132:135], v24, s[56:59], s99 offen offset:1024 nt
    buffer_load_dwordx4 v[136:139], v24, s[56:59], s99 offen offset:2048 nt
    buffer_load_dwordx4 v[140:143], v24, s[56:59], s99 offen offset:3072 nt
    s_add_u32 s99, s99, 4096
    buffer_load_dwordx4 v[144:147], v24, s[56:59], s99 offen offset:0 nt
    buffer_load_dwordx4 v[148:151], v24, s[56:59], s99 offen offset:1024 nt
    buffer_load_dwordx4 v[152:155], v24, s[56:59], s99 offen offset:2048 nt
    buffer_load_dwordx4 v[156:159], v24, s[56:59], s99 offen offset:3072 nt
    s_add_u32 s99, s99, 61440
    buffer_load_dwordx4 v[160:163], v24, s[56:59], s99 offen offset:0 nt
    buffer_load_dwordx4 v[164:167], v24, s[56:59], s99 offen offset:1024 nt
    buffer_load_dwordx4 v[168:171], v24, s[56:59], s99 offen offset:2048 nt
    buffer_load_dwordx4 v[172:175], v24, s[56:59], s99 offen offset:3072 nt
    s_add_u32 s99, s99, 4096
    buffer_load_dwordx4 v[176:179], v24, s[56:59], s99 offen offset:0 nt
    buffer_load_dwordx4 v[180:183], v24, s[56:59], s99 offen offset:1024 nt
    buffer_load_dwordx4 v[184:187], v24, s[56:59], s99 offen offset:2048 nt
    s_waitcnt vmcnt(14)
    s_lshl_b32 s8, s7, 11
    s_add_u32 s8, s8, 9728
    v_lshrrev_b32 v30, 1, v3
    v_lshlrev_b32 v30, 10, v30
    v_lshlrev_b32 v31, 3, v6
    v_add3_u32 v30, v30, v31, s8
    s_lshl_b32 s8, s7, 2
    s_add_u32 s8, s8, 9728
    v_add_u32 v31, s8, v25
    s_waitcnt lgkmcnt(0)
    s_add_u32 s12, s12, 0x9E3779B9
    s_mov_b32 s8, 2
    v_mov_b32 v34, s8
    s_lshl_b32 s9, s7, 2
    v_mov_b32 v35, s9
    s_mov_b64 exec, 1
    ds_write_b32 v35, v34 offset:16
    s_mov_b64 exec, -1
    s_cmp_lg_u32 s7, 0
    s_cbranch_scc1 L_w0_28
    s_mov_b32 s8, 2
    v_mov_b32 v40, 0
    s_mov_b32 s13, 100000
L_lf_29:
    ds_read_b128 v[36:39], v40 offset:16
    s_waitcnt lgkmcnt(0)
    v_xor_b32 v36, s8, v36
    v_xor_b32 v37, s8, v37
    v_xor_b32 v38, s8, v38
    v_xor_b32 v39, s8, v39
    v_or3_b32 v36, v36, v37, v38
    v_or_b32 v36, v36, v39
    v_cmp_ne_u32 vcc, 0, v36
    s_cbranch_vccz L_lf_29_done
    s_sub_u32 s13, s13, 1
    s_cbranch_scc0 L_lf_29
L_lf_29_done:
    s_mov_b32 s68, s40
    s_mov_b32 s69, s41
    s_mov_b32 s70, 256
    s_mov_b32 s71, 0x20000
    v_mov_b32 v36, 1
    s_mov_b64 exec, 1
    buffer_atomic_add v36, v28, s[68:71], 0 offen sc1
    s_mov_b64 exec, -1
L_w0_28:
    buffer_load_dwordx4 v[188:191], v24, s[56:59], s99 offen offset:3072 nt
    s_lshl_b32 s8, s7, 7
    v_subrev_u32 v94, s8, v4
    v_lshlrev_b32 v94, 1, v94
    v_and_b32 v95, 3, v2
    v_lshlrev_b32 v93, 16, v95
    v_add_u32 v94, v94, v93
    v_lshlrev_b32 v95, 10, v95
    s_waitcnt vmcnt(8)
    v_perm_b32 v192, v132, v128, s92
    v_perm_b32 v193, v140, v136, s92
    v_perm_b32 v194, v148, v144, s92
    v_perm_b32 v195, v156, v152, s92
    v_perm_b32 v196, v132, v128, s93
    v_perm_b32 v197, v140, v136, s93
    v_perm_b32 v198, v148, v144, s93
    v_perm_b32 v199, v156, v152, s93
    v_perm_b32 v200, v133, v129, s92
    v_perm_b32 v201, v141, v137, s92
    v_perm_b32 v202, v149, v145, s92
    v_perm_b32 v203, v157, v153, s92
    v_perm_b32 v204, v133, v129, s93
    v_perm_b32 v205, v141, v137, s93
    v_perm_b32 v206, v149, v145, s93
    v_perm_b32 v207, v157, v153, s93
    v_perm_b32 v208, v134, v130, s92
    v_perm_b32 v209, v142, v138, s92
    v_perm_b32 v210, v150, v146, s92
    v_perm_b32 v211, v158, v154, s92
    v_perm_b32 v212, v134, v130, s93
    v_perm_b32 v213, v142, v138, s93
    v_perm_b32 v214, v150, v146, s93
    v_perm_b32 v215, v158, v154, s93
    v_perm_b32 v216, v135, v131, s92
    v_perm_b32 v217, v143, v139, s92
    v_perm_b32 v218, v151, v147, s92
    v_perm_b32 v219, v159, v155, s92
    v_perm_b32 v220, v135, v131, s93
    v_perm_b32 v221, v143, v139, s93
    v_perm_b32 v222, v151, v147, s93
    v_perm_b32 v223, v159, v155, s93
    s_waitcnt vmcnt(0)
    v_perm_b32 v128, v164, v160, s92
    v_perm_b32 v129, v172, v168, s92
    v_perm_b32 v130, v180, v176, s92
    v_perm_b32 v131, v188, v184, s92
    v_perm_b32 v132, v164, v160, s93
    v_perm_b32 v133, v172, v168, s93
    v_perm_b32 v134, v180, v176, s93
    v_perm_b32 v135, v188, v184, s93
    v_perm_b32 v136, v165, v161, s92
    v_perm_b32 v137, v173, v169, s92
    v_perm_b32 v138, v181, v177, s92
    v_perm_b32 v139, v189, v185, s92
    v_perm_b32 v140, v165, v161, s93
    v_perm_b32 v141, v173, v169, s93
    v_perm_b32 v142, v181, v177, s93
    v_perm_b32 v143, v189, v185, s93
    v_perm_b32 v144, v166, v162, s92
    v_perm_b32 v145, v174, v170, s92
    v_perm_b32 v146, v182, v178, s92
    v_perm_b32 v147, v190, v186, s92
    v_perm_b32 v148, v166, v162, s93
    v_perm_b32 v149, v174, v170, s93
    v_perm_b32 v150, v182, v178, s93
    v_perm_b32 v151, v190, v186, s93
    v_perm_b32 v152, v167, v163, s92
    v_perm_b32 v153, v175, v171, s92
    v_perm_b32 v154, v183, v179, s92
    v_perm_b32 v155, v191, v187, s92
    v_perm_b32 v156, v167, v163, s93
    v_perm_b32 v157, v175, v171, s93
    v_perm_b32 v158, v183, v179, s93
    v_perm_b32 v159, v191, v187, s93
    s_lshl_b32 s96, s95, 11
    s_add_u32 s96, s96, 65536
    s_lshl_b32 s8, s7, 9
    s_add_u32 s96, s96, s8
    s_lshl_b32 s8, s7, 8
    s_add_u32 s8, s8, 256
    v_add_u32 v33, s8, v26
    s_mov_b32 s13, 100000
L_pq_30:
    buffer_load_dwordx2 v[40:41], v27, s[44:47], s96 offen sc1
    s_waitcnt vmcnt(0)
    v_cmp_ne_u32 vcc, s12, v41
    s_cbranch_vccz L_pq_30_done
    s_sleep 16
    s_sub_u32 s13, s13, 1
    s_cbranch_scc0 L_pq_30
L_pq_30_done:
    ds_write_b32 v33, v40
    s_waitcnt lgkmcnt(0)
    s_mov_b32 s8, 3
    v_mov_b32 v34, s8
    s_lshl_b32 s9, s7, 2
    v_mov_b32 v35, s9
    s_mov_b64 exec, 1
    ds_write_b32 v35, v34 offset:32
    s_mov_b64 exec, -1
    s_cmp_lg_u32 s7, 0
    s_cbranch_scc1 L_w0_31
    s_mov_b32 s68, s40
    s_mov_b32 s69, s41
    s_mov_b32 s70, 256
    s_mov_b32 s71, 0x20000
    s_mov_b32 s13, 100000
L_pa_32:
    buffer_load_dword v40, v28, s[68:71], 0 offen sc1
    s_waitcnt vmcnt(0)
    v_cmp_gt_u32 vcc, 0x100, v40
    s_cbranch_vccz L_pa_32_done
    s_sleep 16
    s_sub_u32 s13, s13, 1
    s_cbranch_scc0 L_pa_32
L_pa_32_done:
    s_cmp_lg_u32 s2, 0
    s_cbranch_scc1 L_noep_33
    v_mov_b32 v40, s12
    s_mov_b64 exec, 1
    buffer_store_dword v40, v28, s[44:47], 0 offen offset:0 sc1
    s_mov_b64 exec, -1
L_noep_33:
L_w0_31:
    s_lshl_b32 s96, s90, 13
    s_lshl_b32 s8, s7, 8
    s_add_u32 s96, s96, s8
    s_add_u32 s96, s96, 131072
    s_add_u32 s97, s96, 4096
    s_lshl_b32 s98, s90, 7
    s_lshl_b32 s8, s7, 5
    s_add_u32 s98, s98, s8
    s_add_u32 s98, s98, 393216
    s_lshl_b32 s99, s7, 13
    s_lshl_b32 s8, s90, 10
    s_add_u32 s99, s99, s8
    s_lshl_b32 s8, s91, 7
    s_add_u32 s99, s99, s8
    s_add_u32 s99, s99, 458752
    v_lshlrev_b32 v26, 1, v0
    s_mov_b64 s[52:53], -1
    s_mov_b64 s[54:55], -1
    s_mov_b64 s[56:57], -1
    s_mov_b64 s[58:59], -1
    s_mov_b64 s[60:61], -1
    s_mov_b64 s[62:63], -1
    s_mov_b64 s[64:65], -1
    s_mov_b64 s[66:67], -1
    s_mov_b64 s[68:69], -1
    s_mov_b64 s[70:71], -1
    s_barrier
    s_mov_b32 s13, 100000
L_h1_34:
    s_mov_b64 exec, s[68:69]
    s_cbranch_execz L_ml_35
    buffer_load_dwordx4 v[224:227], v95, s[44:47], s98 offen offset:0 sc1
L_ml_35:
    s_mov_b64 exec, s[70:71]
    s_cbranch_execz L_ml_36
    buffer_load_dwordx4 v[228:231], v95, s[44:47], s98 offen offset:16 sc1
L_ml_36:
    s_mov_b64 exec, s[52:53]
    s_cbranch_execz L_ml_37
    buffer_load_dwordx4 v[160:163], v94, s[44:47], s96 offen offset:0 sc1
L_ml_37:
    s_mov_b64 exec, s[54:55]
    s_cbranch_execz L_ml_38
    buffer_load_dwordx4 v[164:167], v94, s[44:47], s96 offen offset:1024 sc1
L_ml_38:
    s_mov_b64 exec, s[56:57]
    s_cbranch_execz L_ml_39
    buffer_load_dwordx4 v[168:171], v94, s[44:47], s96 offen offset:2048 sc1
L_ml_39:
    s_mov_b64 exec, s[58:59]
    s_cbranch_execz L_ml_40
    buffer_load_dwordx4 v[172:175], v94, s[44:47], s96 offen offset:3072 sc1
L_ml_40:
    s_mov_b64 exec, s[60:61]
    s_cbranch_execz L_ml_41
    buffer_load_dwordx4 v[176:179], v94, s[44:47], s97 offen offset:0 sc1
L_ml_41:
    s_mov_b64 exec, s[62:63]
    s_cbranch_execz L_ml_42
    buffer_load_dwordx4 v[180:183], v94, s[44:47], s97 offen offset:1024 sc1
L_ml_42:
    s_mov_b64 exec, s[64:65]
    s_cbranch_execz L_ml_43
    buffer_load_dwordx4 v[184:187], v94, s[44:47], s97 offen offset:2048 sc1
L_ml_43:
    s_mov_b64 exec, s[66:67]
    s_cbranch_execz L_ml_44
    buffer_load_dwordx4 v[188:191], v94, s[44:47], s97 offen offset:3072 sc1
L_ml_44:
    s_mov_b64 exec, -1
    s_waitcnt vmcnt(0)
    v_max3_u32 v80, v224, v225, v226
    v_max_u32 v80, v80, v227
    v_cmp_eq_u32 s[68:69], -1, v80
    v_max3_u32 v81, v228, v229, v230
    v_max_u32 v81, v81, v231
    v_cmp_eq_u32 s[70:71], -1, v81
    v_max3_u32 v80, v160, v161, v162
    v_max_u32 v80, v80, v163
    v_cmp_eq_u32 s[52:53], -1, v80
    v_max3_u32 v81, v164, v165, v166
    v_max_u32 v81, v81, v167
    v_cmp_eq_u32 s[54:55], -1, v81
    v_max3_u32 v80, v168, v169, v170
    v_max_u32 v80, v80, v171
    v_cmp_eq_u32 s[56:57], -1, v80
    v_max3_u32 v81, v172, v173, v174
    v_max_u32 v81, v81, v175
    v_cmp_eq_u32 s[58:59], -1, v81
    v_max3_u32 v80, v176, v177, v178
    v_max_u32 v80, v80, v179
    v_cmp_eq_u32 s[60:61], -1, v80
    v_max3_u32 v81, v180, v181, v182
    v_max_u32 v81, v81, v183
    v_cmp_eq_u32 s[62:63], -1, v81
    v_max3_u32 v80, v184, v185, v186
    v_max_u32 v80, v80, v187
    v_cmp_eq_u32 s[64:65], -1, v80
    v_max3_u32 v81, v188, v189, v190
    v_max_u32 v81, v81, v191
    v_cmp_eq_u32 s[66:67], -1, v81
    s_or_b64 s[100:101], s[68:69], s[70:71]
    s_or_b64 s[100:101], s[100:101], s[52:53]
    s_or_b64 s[100:101], s[100:101], s[54:55]
    s_or_b64 s[100:101], s[100:101], s[56:57]
    s_or_b64 s[100:101], s[100:101], s[58:59]
    s_or_b64 s[100:101], s[100:101], s[60:61]
    s_or_b64 s[100:101], s[100:101], s[62:63]
    s_or_b64 s[100:101], s[100:101], s[64:65]
    s_or_b64 s[100:101], s[100:101], s[66:67]
    s_cbranch_scc0 L_h1_34_done
    s_sub_u32 s13, s13, 1
    s_cbranch_scc0 L_h1_34
L_h1_34_done:
    v_max3_f32 v80, v224, v225, v226
    v_max3_f32 v81, v227, v228, v229
    v_max3_f32 v80, v80, v230, v231
    v_max_f32 v80, v80, v81
    v_sub_f32 v64, v224, v80
    v_sub_f32 v65, v225, v80
    v_sub_f32 v66, v226, v80
    v_sub_f32 v67, v227, v80
    v_sub_f32 v68, v228, v80
    v_sub_f32 v69, v229, v80
    v_sub_f32 v70, v230, v80
    v_sub_f32 v71, v231, v80
    v_exp_f32 v64, v64
    v_exp_f32 v65, v65
    v_exp_f32 v66, v66
    v_exp_f32 v67, v67
    v_exp_f32 v68, v68
    v_exp_f32 v69, v69
    v_exp_f32 v70, v70
    v_exp_f32 v71, v71
    v_lshlrev_b32 v82, 16, v160
    v_and_b32 v83, s14, v160
    v_lshlrev_b32 v84, 16, v161
    v_and_b32 v85, s14, v161
    v_lshlrev_b32 v86, 16, v162
    v_and_b32 v87, s14, v162
    v_lshlrev_b32 v88, 16, v163
    v_and_b32 v89, s14, v163
    v_add_f32 v80, v64, v65
    v_add_f32 v81, v66, v67
    v_add_f32 v90, v68, v69
    v_add_f32 v91, v70, v71
    v_add_f32 v80, v80, v81
    v_add_f32 v90, v90, v91
    v_add_f32 v80, v80, v90
    v_rcp_f32 v80, v80
    v_pk_mul_f32 v[72:73], v[64:65], v[82:83] op_sel:[0,0] op_sel_hi:[0,1]
    v_pk_mul_f32 v[74:75], v[64:65], v[84:85] op_sel:[0,0] op_sel_hi:[0,1]
    v_pk_mul_f32 v[76:77], v[64:65], v[86:87] op_sel:[0,0] op_sel_hi:[0,1]
    v_pk_mul_f32 v[78:79], v[64:65], v[88:89] op_sel:[0,0] op_sel_hi:[0,1]
    v_lshlrev_b32 v82, 16, v164
    v_and_b32 v83, s14, v164
    v_lshlrev_b32 v84, 16, v165
    v_and_b32 v85, s14, v165
    v_lshlrev_b32 v86, 16, v166
    v_and_b32 v87, s14, v166
    v_lshlrev_b32 v88, 16, v167
    v_and_b32 v89, s14, v167
    v_pk_fma_f32 v[72:73], v[64:65], v[82:83], v[72:73] op_sel:[1,0,0] op_sel_hi:[1,1,1]
    v_pk_fma_f32 v[74:75], v[64:65], v[84:85], v[74:75] op_sel:[1,0,0] op_sel_hi:[1,1,1]
    v_pk_fma_f32 v[76:77], v[64:65], v[86:87], v[76:77] op_sel:[1,0,0] op_sel_hi:[1,1,1]
    v_pk_fma_f32 v[78:79], v[64:65], v[88:89], v[78:79] op_sel:[1,0,0] op_sel_hi:[1,1,1]
    v_lshlrev_b32 v82, 16, v168
    v_and_b32 v83, s14, v168
    v_lshlrev_b32 v84, 16, v169
    v_and_b32 v85, s14, v169
    v_lshlrev_b32 v86, 16, v170
    v_and_b32 v87, s14, v170
    v_lshlrev_b32 v88, 16, v171
    v_and_b32 v89, s14, v171
    v_pk_fma_f32 v[72:73], v[66:67], v[82:83], v[72:73] op_sel:[0,0,0] op_sel_hi:[0,1,1]
    v_pk_fma_f32 v[74:75], v[66:67], v[84:85], v[74:75] op_sel:[0,0,0] op_sel_hi:[0,1,1]
    v_pk_fma_f32 v[76:77], v[66:67], v[86:87], v[76:77] op_sel:[0,0,0] op_sel_hi:[0,1,1]
    v_pk_fma_f32 v[78:79], v[66:67], v[88:89], v[78:79] op_sel:[0,0,0] op_sel_hi:[0,1,1]
    v_lshlrev_b32 v82, 16, v172
    v_and_b32 v83, s14, v172
    v_lshlrev_b32 v84, 16, v173
    v_and_b32 v85, s14, v173
    v_lshlrev_b32 v86, 16, v174
    v_and_b32 v87, s14, v174
    v_lshlrev_b32 v88, 16, v175
    v_and_b32 v89, s14, v175
    v_pk_fma_f32 v[72:73], v[66:67], v[82:83], v[72:73] op_sel:[1,0,0] op_sel_hi:[1,1,1]
    v_pk_fma_f32 v[74:75], v[66:67], v[84:85], v[74:75] op_sel:[1,0,0] op_sel_hi:[1,1,1]
    v_pk_fma_f32 v[76:77], v[66:67], v[86:87], v[76:77] op_sel:[1,0,0] op_sel_hi:[1,1,1]
    v_pk_fma_f32 v[78:79], v[66:67], v[88:89], v[78:79] op_sel:[1,0,0] op_sel_hi:[1,1,1]
    v_lshlrev_b32 v82, 16, v176
    v_and_b32 v83, s14, v176
    v_lshlrev_b32 v84, 16, v177
    v_and_b32 v85, s14, v177
    v_lshlrev_b32 v86, 16, v178
    v_and_b32 v87, s14, v178
    v_lshlrev_b32 v88, 16, v179
    v_and_b32 v89, s14, v179
    v_pk_fma_f32 v[72:73], v[68:69], v[82:83], v[72:73] op_sel:[0,0,0] op_sel_hi:[0,1,1]
    v_pk_fma_f32 v[74:75], v[68:69], v[84:85], v[74:75] op_sel:[0,0,0] op_sel_hi:[0,1,1]
    v_pk_fma_f32 v[76:77], v[68:69], v[86:87], v[76:77] op_sel:[0,0,0] op_sel_hi:[0,1,1]
    v_pk_fma_f32 v[78:79], v[68:69], v[88:89], v[78:79] op_sel:[0,0,0] op_sel_hi:[0,1,1]
    v_lshlrev_b32 v82, 16, v180
    v_and_b32 v83, s14, v180
    v_lshlrev_b32 v84, 16, v181
    v_and_b32 v85, s14, v181
    v_lshlrev_b32 v86, 16, v182
    v_and_b32 v87, s14, v182
    v_lshlrev_b32 v88, 16, v183
    v_and_b32 v89, s14, v183
    v_pk_fma_f32 v[72:73], v[68:69], v[82:83], v[72:73] op_sel:[1,0,0] op_sel_hi:[1,1,1]
    v_pk_fma_f32 v[74:75], v[68:69], v[84:85], v[74:75] op_sel:[1,0,0] op_sel_hi:[1,1,1]
    v_pk_fma_f32 v[76:77], v[68:69], v[86:87], v[76:77] op_sel:[1,0,0] op_sel_hi:[1,1,1]
    v_pk_fma_f32 v[78:79], v[68:69], v[88:89], v[78:79] op_sel:[1,0,0] op_sel_hi:[1,1,1]
    v_lshlrev_b32 v82, 16, v184
    v_and_b32 v83, s14, v184
    v_lshlrev_b32 v84, 16, v185
    v_and_b32 v85, s14, v185
    v_lshlrev_b32 v86, 16, v186
    v_and_b32 v87, s14, v186
    v_lshlrev_b32 v88, 16, v187
    v_and_b32 v89, s14, v187
    v_pk_fma_f32 v[72:73], v[70:71], v[82:83], v[72:73] op_sel:[0,0,0] op_sel_hi:[0,1,1]
    v_pk_fma_f32 v[74:75], v[70:71], v[84:85], v[74:75] op_sel:[0,0,0] op_sel_hi:[0,1,1]
    v_pk_fma_f32 v[76:77], v[70:71], v[86:87], v[76:77] op_sel:[0,0,0] op_sel_hi:[0,1,1]
    v_pk_fma_f32 v[78:79], v[70:71], v[88:89], v[78:79] op_sel:[0,0,0] op_sel_hi:[0,1,1]
    v_lshlrev_b32 v82, 16, v188
    v_and_b32 v83, s14, v188
    v_lshlrev_b32 v84, 16, v189
    v_and_b32 v85, s14, v189
    v_lshlrev_b32 v86, 16, v190
    v_and_b32 v87, s14, v190
    v_lshlrev_b32 v88, 16, v191
    v_and_b32 v89, s14, v191
    v_pk_fma_f32 v[72:73], v[70:71], v[82:83], v[72:73] op_sel:[1,0,0] op_sel_hi:[1,1,1]
    v_pk_fma_f32 v[74:75], v[70:71], v[84:85], v[74:75] op_sel:[1,0,0] op_sel_hi:[1,1,1]
    v_pk_fma_f32 v[76:77], v[70:71], v[86:87], v[76:77] op_sel:[1,0,0] op_sel_hi:[1,1,1]
    v_pk_fma_f32 v[78:79], v[70:71], v[88:89], v[78:79] op_sel:[1,0,0] op_sel_hi:[1,1,1]
    v_mul_f32 v72, v72, v80
    v_mul_f32 v73, v73, v80
    v_mul_f32 v74, v74, v80
    v_mul_f32 v75, v75, v80
    v_mul_f32 v76, v76, v80
    v_mul_f32 v77, v77, v80
    v_mul_f32 v78, v78, v80
    v_mul_f32 v79, v79, v80
    v_cvt_pk_bf16_f32 v16, v72, v73
    v_cvt_pk_bf16_f32 v17, v74, v75
    v_cvt_pk_bf16_f32 v18, v76, v77
    v_cvt_pk_bf16_f32 v19, v78, v79
    s_nop 1
    v_mov_b32_dpp v12, v16 row_shl:4 row_mask:0xf bank_mask:0xf
    v_mov_b32_dpp v13, v17 row_shl:4 row_mask:0xf bank_mask:0xf
    v_mov_b32_dpp v14, v18 row_shl:4 row_mask:0xf bank_mask:0xf
    v_mov_b32_dpp v15, v19 row_shl:4 row_mask:0xf bank_mask:0xf
    v_mfma_f32_16x16x32_bf16 v[96:99], v[16:19], v[192:195], 0
    v_mfma_f32_16x16x32_bf16 v[100:103], v[16:19], v[196:199], 0
    v_mfma_f32_16x16x32_bf16 v[104:107], v[16:19], v[200:203], 0
    v_mfma_f32_16x16x32_bf16 v[108:111], v[16:19], v[204:207], 0
    v_mfma_f32_16x16x32_bf16 v[112:115], v[16:19], v[208:211], 0
    v_mfma_f32_16x16x32_bf16 v[116:119], v[16:19], v[212:215], 0
    v_mfma_f32_16x16x32_bf16 v[120:123], v[16:19], v[216:219], 0
    v_mfma_f32_16x16x32_bf16 v[124:127], v[16:19], v[220:223], 0
    v_mfma_f32_16x16x32_bf16 v[96:99], v[12:15], v[128:131], v[96:99]
    v_mfma_f32_16x16x32_bf16 v[100:103], v[12:15], v[132:135], v[100:103]
    v_mfma_f32_16x16x32_bf16 v[104:107], v[12:15], v[136:139], v[104:107]
    v_mfma_f32_16x16x32_bf16 v[108:111], v[12:15], v[140:143], v[108:111]
    v_mfma_f32_16x16x32_bf16 v[112:115], v[12:15], v[144:147], v[112:115]
    v_mfma_f32_16x16x32_bf16 v[116:119], v[12:15], v[148:151], v[116:119]
    v_mfma_f32_16x16x32_bf16 v[120:123], v[12:15], v[152:155], v[120:123]
    v_mfma_f32_16x16x32_bf16 v[124:127], v[12:15], v[156:159], v[124:127]
    s_mov_b32 exec_lo, 0xff
    s_mov_b32 exec_hi, 0xff00
    ds_write_b128 v30, v[96:99] offset:0
    ds_write_b128 v30, v[100:103] offset:16
    ds_write_b128 v30, v[104:107] offset:32
    ds_write_b128 v30, v[108:111] offset:48
    ds_write_b128 v30, v[112:115] offset:64
    ds_write_b128 v30, v[116:119] offset:80
    ds_write_b128 v30, v[120:123] offset:96
    ds_write_b128 v30, v[124:127] offset:112
    s_mov_b64 exec, -1
    s_waitcnt lgkmcnt(0)
    s_barrier
    ds_read2st64_b32 v[40:41], v31 offset0:0 offset1:4
    ds_read2st64_b32 v[42:43], v31 offset0:8 offset1:12
    ds_read2st64_b32 v[44:45], v31 offset0:16 offset1:20
    ds_read2st64_b32 v[46:47], v31 offset0:24 offset1:28
    s_waitcnt lgkmcnt(2)
    v_add_f32 v40, v40, v41
    v_add_f32 v42, v42, v43
    v_add_f32 v40, v40, v42
    s_waitcnt lgkmcnt(0)
    v_add_f32 v44, v44, v45
    v_add_f32 v46, v46, v47
    v_add_f32 v44, v44, v46
    v_add_f32 v40, v40, v44
    s_nop 1
    v_mov_b32_dpp v44, v40 quad_perm:[0,0,0,0] row_mask:0xf bank_mask:0xf
    v_mov_b32_dpp v45, v40 quad_perm:[1,1,1,1] row_mask:0xf bank_mask:0xf
    v_mov_b32_dpp v46, v40 quad_perm:[2,2,2,2] row_mask:0xf bank_mask:0xf
    v_mov_b32_dpp v47, v40 quad_perm:[3,3,3,3] row_mask:0xf bank_mask:0xf
    v_cvt_pk_bf16_f32 v44, v44, v45
    v_cvt_pk_bf16_f32 v45, v46, v47
    s_mov_b32 exec_lo, 0x11111111
    s_mov_b32 exec_hi, 0x11111111
    buffer_store_dwordx2 v[44:45], v26, s[44:47], s99 offen sc1
    s_mov_b64 exec, -1
    v_lshlrev_b32 v26, 2, v0
    s_endpgm
L_ffn:
    s_mov_b32 s52, s28
    s_mov_b32 s53, s29
    s_mov_b32 s54, 1835008
    s_mov_b32 s55, 0x20000
    s_mov_b32 s56, s30
    s_mov_b32 s57, s31
    s_mov_b32 s58, 1835008
    s_mov_b32 s59, 0x20000
    s_mov_b32 s60, s32
    s_mov_b32 s61, s33
    s_mov_b32 s62, 1835008
    s_mov_b32 s63, 0x20000
    s_mov_b32 s64, s16
    s_mov_b32 s65, s17
    s_mov_b32 s66, 4096
    s_mov_b32 s67, 0x20000
    s_sub_u32 s91, s3, 176
    s_lshr_b32 s91, s91, 3
    s_lshl_b32 s8, s90, 3
    s_add_u32 s91, s91, s8
    s_lshl_b32 s8, s7, 7
    v_lshrrev_b32 v4, 2, v2
    v_lshlrev_b32 v4, 5, v4
    v_lshlrev_b32 v6, 3, v3
    v_add3_u32 v4, v4, v6, s8
    v_and_b32 v6, 3, v2
    v_lshlrev_b32 v6, 4, v6
    s_movk_i32 s9, 3584
    v_mul_lo_u32 v24, v4, s9
    v_add_u32 v24, v24, v6
    v_lshlrev_b32 v5, 13, v3
    v_lshlrev_b32 v30, 3, v2
    v_add_u32 v5, v5, v30
    s_lshl_b32 s10, s7, 10
    buffer_load_dwordx4 v[12:15], v25, s[64:67], s10 offen
    v_lshlrev_b32 v18, 5, v0
    s_mov_b64 exec, s[100:101]
    buffer_store_dwordx4 v[8:11], v29, s[44:47], 0 offen sc1
    s_mov_b64 exec, -1
    s_waitcnt vmcnt(0)
    s_waitcnt lgkmcnt(0)
    s_add_u32 s12, s12, 0x9E3779B9
    s_mov_b32 s8, 2
    v_mov_b32 v34, s8
    s_lshl_b32 s9, s7, 2
    v_mov_b32 v35, s9
    s_mov_b64 exec, 1
    ds_write_b32 v35, v34 offset:16
    s_mov_b64 exec, -1
    s_cmp_lg_u32 s7, 0
    s_cbranch_scc1 L_w0_45
    s_mov_b32 s8, 2
    v_mov_b32 v40, 0
    s_mov_b32 s13, 100000
L_lf_46:
    ds_read_b128 v[36:39], v40 offset:16
    s_waitcnt lgkmcnt(0)
    v_xor_b32 v36, s8, v36
    v_xor_b32 v37, s8, v37
    v_xor_b32 v38, s8, v38
    v_xor_b32 v39, s8, v39
    v_or3_b32 v36, v36, v37, v38
    v_or_b32 v36, v36, v39
    v_cmp_ne_u32 vcc, 0, v36
    s_cbranch_vccz L_lf_46_done
    s_sub_u32 s13, s13, 1
    s_cbranch_scc0 L_lf_46
L_lf_46_done:
    s_mov_b32 s68, s40
    s_mov_b32 s69, s41
    s_mov_b32 s70, 256
    s_mov_b32 s71, 0x20000
    v_mov_b32 v36, 1
    s_mov_b64 exec, 1
    buffer_atomic_add v36, v28, s[68:71], 0 offen sc1
    s_mov_b64 exec, -1
L_w0_45:
    s_lshl_b32 s96, s95, 11
    s_add_u32 s96, s96, 65536
    s_lshl_b32 s8, s7, 9
    s_add_u32 s96, s96, s8
    s_lshl_b32 s8, s7, 8
    s_add_u32 s8, s8, 256
    v_add_u32 v33, s8, v26
    s_mov_b32 s13, 100000
L_pq_47:
    buffer_load_dwordx2 v[40:41], v27, s[44:47], s96 offen sc1
    s_waitcnt vmcnt(0)
    v_cmp_ne_u32 vcc, s12, v41
    s_cbranch_vccz L_pq_47_done
    s_sleep 16
    s_sub_u32 s13, s13, 1
    s_cbranch_scc0 L_pq_47
L_pq_47_done:
    ds_write_b32 v33, v40
    s_waitcnt lgkmcnt(0)
    s_mov_b32 s8, 3
    v_mov_b32 v34, s8
    s_lshl_b32 s9, s7, 2
    v_mov_b32 v35, s9
    s_mov_b64 exec, 1
    ds_write_b32 v35, v34 offset:32
    s_mov_b64 exec, -1
    s_lshl_b32 s8, s7, 12
    s_add_u32 s8, s8, 9728
    v_and_b32 v30, 1, v2
    v_lshlrev_b32 v30, 11, v30
    v_and_b32 v31, 12, v2
    v_lshlrev_b32 v31, 4, v31
    v_add_u32 v30, v30, v31
    v_lshlrev_b32 v32, 4, v3
    v_add3_u32 v30, v30, v32, s8
    v_lshlrev_b32 v31, 8, v2
    v_add3_u32 v31, v31, v32, s8
    v_lshlrev_b32 v32, 16, v12
    v_and_b32 v33, s14, v12
    v_lshlrev_b32 v34, 16, v13
    v_and_b32 v35, s14, v13
    v_lshlrev_b32 v36, 16, v14
    v_and_b32 v37, s14, v14
    v_lshlrev_b32 v38, 16, v15
    v_and_b32 v39, s14, v15
    s_mul_i32 s96, s7, 12288
    s_add_u32 s96, s96, 8192
    s_add_u32 s97, s96, 4096
    s_mov_b32 s13, 100000
L_pc_48:
    buffer_load_dwordx4 v[64:67], v18, s[44:47], s96 offen offset:0 sc1
    buffer_load_dwordx4 v[68:71], v18, s[44:47], s96 offen offset:16 sc1
    buffer_load_dwordx4 v[72:75], v18, s[44:47], s96 offen offset:2048 sc1
    buffer_load_dwordx4 v[76:79], v18, s[44:47], s96 offen offset:2064 sc1
    buffer_load_dwordx4 v[80:83], v18, s[44:47], s97 offen offset:0 sc1
    buffer_load_dwordx4 v[84:87], v18, s[44:47], s97 offen offset:16 sc1
    s_waitcnt vmcnt(0)
    v_xor_b32 v65, s12, v65
    v_xor_b32 v67, s12, v67
    v_xor_b32 v69, s12, v69
    v_xor_b32 v71, s12, v71
    v_xor_b32 v73, s12, v73
    v_xor_b32 v75, s12, v75
    v_xor_b32 v77, s12, v77
    v_xor_b32 v79, s12, v79
    v_xor_b32 v81, s12, v81
    v_xor_b32 v83, s12, v83
    v_xor_b32 v85, s12, v85
    v_xor_b32 v87, s12, v87
    v_or3_b32 v65, v65, v67, v69
    v_or3_b32 v65, v65, v71, v73
    v_or3_b32 v65, v65, v75, v77
    v_or3_b32 v65, v65, v79, v81
    v_or3_b32 v65, v65, v83, v85
    v_or_b32 v65, v65, v87
    v_cmp_ne_u32 vcc, 0, v65
    s_cbranch_vccz L_pc_48_done
    s_sleep 16
    s_sub_u32 s13, s13, 1
    s_cbranch_scc0 L_pc_48
L_pc_48_done:
    v_lshlrev_b32 v40, 16, v64
    v_and_b32 v41, s14, v64
    v_lshlrev_b32 v56, 16, v72
    v_and_b32 v57, s14, v72
    v_lshlrev_b32 v48, 16, v80
    v_and_b32 v49, s14, v80
    v_lshlrev_b32 v42, 16, v66
    v_and_b32 v43, s14, v66
    v_lshlrev_b32 v58, 16, v74
    v_and_b32 v59, s14, v74
    v_lshlrev_b32 v50, 16, v82
    v_and_b32 v51, s14, v82
    v_lshlrev_b32 v44, 16, v68
    v_and_b32 v45, s14, v68
    v_lshlrev_b32 v60, 16, v76
    v_and_b32 v61, s14, v76
    v_lshlrev_b32 v52, 16, v84
    v_and_b32 v53, s14, v84
    v_lshlrev_b32 v46, 16, v70
    v_and_b32 v47, s14, v70
    v_lshlrev_b32 v62, 16, v78
    v_and_b32 v63, s14, v78
    v_lshlrev_b32 v54, 16, v86
    v_and_b32 v55, s14, v86
    v_add_f32 v48, 1.0, v48
    v_add_f32 v49, 1.0, v49
    v_add_f32 v50, 1.0, v50
    v_add_f32 v51, 1.0, v51
    v_add_f32 v52, 1.0, v52
    v_add_f32 v53, 1.0, v53
    v_add_f32 v54, 1.0, v54
    v_add_f32 v55, 1.0, v55
    v_cvt_pk_bf16_f32 v64, v48, v49
    v_lshlrev_b32 v48, 16, v64
    v_and_b32 v49, s14, v64
    v_cvt_pk_bf16_f32 v64, v50, v51
    v_lshlrev_b32 v50, 16, v64
    v_and_b32 v51, s14, v64
    v_cvt_pk_bf16_f32 v64, v52, v53
    v_lshlrev_b32 v52, 16, v64
    v_and_b32 v53, s14, v64
    v_cvt_pk_bf16_f32 v64, v54, v55
    v_lshlrev_b32 v54, 16, v64
    v_and_b32 v55, s14, v64
    s_cmp_lg_u32 s7, 0
    s_cbranch_scc1 L_w0_49
    v_mov_b32 v192, v40
    s_mov_b32 s68, s40
    s_mov_b32 s69, s41
    s_mov_b32 s70, 256
    s_mov_b32 s71, 0x20000
    s_mov_b32 s13, 100000
L_pa_50:
    buffer_load_dword v40, v28, s[68:71], 0 offen sc1
    s_waitcnt vmcnt(0)
    v_cmp_gt_u32 vcc, 0x100, v40
    s_cbranch_vccz L_pa_50_done
    s_sleep 16
    s_sub_u32 s13, s13, 1
    s_cbranch_scc0 L_pa_50
L_pa_50_done:
    s_cmp_lg_u32 s2, 0
    s_cbranch_scc1 L_noep_51
    v_mov_b32 v40, s12
    s_mov_b64 exec, 1
    buffer_store_dword v40, v28, s[44:47], 0 offen offset:0 sc1
    s_mov_b64 exec, -1
L_noep_51:
    v_mov_b32 v40, v192
L_w0_49:
    s_lshl_b32 s8, s7, 10
    s_add_u32 s8, s8, 9728
    v_add_u32 v12, s8, v25
    s_lshl_b32 s8, s7, 8
    s_add_u32 s8, s8, 9728
    v_and_b32 v13, 12, v2
    v_lshlrev_b32 v13, 8, v13
    v_lshlrev_b32 v14, 4, v3
    v_add3_u32 v13, v13, v14, s8
    s_lshl_b32 s8, s7, 10
    s_add_u32 s8, s8, 13824
    v_lshlrev_b32 v14, 7, v3
    v_lshlrev_b32 v15, 2, v2
    v_add3_u32 v14, v14, v15, s8
    v_and_b32 v15, 2, v2
    v_lshlrev_b32 v15, 8, v15
    v_and_b32 v16, 12, v2
    v_lshlrev_b32 v16, 5, v16
    v_add_u32 v15, v15, v16
    v_lshlrev_b32 v16, 5, v3
    v_and_b32 v17, 1, v2
    v_lshlrev_b32 v17, 4, v17
    v_add3_u32 v15, v15, v16, v17
    v_add_u32 v15, 13824, v15
    v_lshlrev_b32 v16, 17, v3
    v_and_b32 v17, 8, v2
    v_lshlrev_b32 v17, 10, v17
    v_add_u32 v16, v16, v17
    v_and_b32 v17, 7, v2
    v_lshlrev_b32 v17, 4, v17
    v_add_u32 v16, v16, v17
    s_lshl_b32 s8, s7, 14
    s_add_u32 s8, s8, 32768
    v_and_b32 v80, 3, v2
    v_lshlrev_b32 v81, 11, v80
    v_lshrrev_b32 v82, 1, v80
    v_and_b32 v80, 1, v80
    v_lshl_or_b32 v82, v80, 1, v82
    v_and_b32 v83, 12, v2
    v_or_b32 v83, v83, v3
    v_xor_b32 v83, v83, v82
    v_lshl_or_b32 v81, v83, 4, v81
    v_add_u32 v64, s8, v81
    v_xor_b32 v65, 16, v64
    v_xor_b32 v66, 64, v64
    v_xor_b32 v67, 80, v64
    v_xor_b32 v68, 128, v64
    v_xor_b32 v69, 144, v64
    v_xor_b32 v70, 192, v64
    v_xor_b32 v71, 208, v64
    v_and_b32 v80, 1, v2
    v_lshrrev_b32 v81, 2, v2
    v_and_b32 v81, 2, v81
    v_or_b32 v80, v80, v81
    v_and_b32 v81, 6, v2
    v_lshl_or_b32 v80, v81, 1, v80
    v_xor_b32 v80, v80, v3
    v_lshlrev_b32 v81, 8, v2
    v_lshl_or_b32 v81, v80, 4, v81
    v_add_u32 v72, s8, v81
    v_xor_b32 v73, 64, v72
    v_xor_b32 v74, 128, v72
    v_xor_b32 v75, 192, v72
    v_xor_b32 v76, 16, v72
    v_xor_b32 v77, 80, v72
    v_xor_b32 v78, 144, v72
    v_xor_b32 v79, 208, v72
    s_barrier
    s_barrier
    s_lshl_b32 s99, s91, 6
    buffer_load_dwordx4 v[128:131], v24, s[52:55], s99 offen offset:0
    buffer_load_dwordx4 v[132:135], v24, s[52:55], s99 offen offset:3584
    s_add_u32 s99, s99, 7168
    buffer_load_dwordx4 v[136:139], v24, s[52:55], s99 offen offset:0
    buffer_load_dwordx4 v[140:143], v24, s[52:55], s99 offen offset:3584
    s_add_u32 s99, s99, 7168
    buffer_load_dwordx4 v[144:147], v24, s[52:55], s99 offen offset:0
    buffer_load_dwordx4 v[148:151], v24, s[52:55], s99 offen offset:3584
    s_add_u32 s99, s99, 7168
    buffer_load_dwordx4 v[152:155], v24, s[52:55], s99 offen offset:0
    buffer_load_dwordx4 v[156:159], v24, s[52:55], s99 offen offset:3584
    s_lshl_b32 s99, s91, 6
    buffer_load_dwordx4 v[160:163], v24, s[56:59], s99 offen offset:0
    buffer_load_dwordx4 v[164:167], v24, s[56:59], s99 offen offset:3584
    s_add_u32 s99, s99, 7168
    buffer_load_dwordx4 v[168:171], v24, s[56:59], s99 offen offset:0
    buffer_load_dwordx4 v[172:175], v24, s[56:59], s99 offen offset:3584
    s_add_u32 s99, s99, 7168
    buffer_load_dwordx4 v[176:179], v24, s[56:59], s99 offen offset:0
    buffer_load_dwordx4 v[180:183], v24, s[56:59], s99 offen offset:3584
    s_add_u32 s99, s99, 7168
    buffer_load_dwordx4 v[184:187], v24, s[56:59], s99 offen offset:0
    buffer_load_dwordx4 v[188:191], v24, s[56:59], s99 offen offset:3584
    s_lshl_b32 s99, s91, 15
    s_lshl_b32 s11, s7, 8
    s_add_u32 s99, s99, s11
    buffer_load_dwordx2 v[192:193], v5, s[60:63], s99 offen offset:0 nt
    buffer_load_dwordx2 v[194:195], v5, s[60:63], s99 offen offset:128 nt
    buffer_load_dwordx2 v[196:197], v5, s[60:63], s99 offen offset:1024 nt
    buffer_load_dwordx2 v[198:199], v5, s[60:63], s99 offen offset:1152 nt
    buffer_load_dwordx2 v[200:201], v5, s[60:63], s99 offen offset:2048 nt
    buffer_load_dwordx2 v[202:203], v5, s[60:63], s99 offen offset:2176 nt
    buffer_load_dwordx2 v[204:205], v5, s[60:63], s99 offen offset:3072 nt
    buffer_load_dwordx2 v[206:207], v5, s[60:63], s99 offen offset:3200 nt
    s_add_u32 s99, s99, 4096
    buffer_load_dwordx2 v[208:209], v5, s[60:63], s99 offen offset:0 nt
    buffer_load_dwordx2 v[210:211], v5, s[60:63], s99 offen offset:128 nt
    buffer_load_dwordx2 v[212:213], v5, s[60:63], s99 offen offset:1024 nt
    buffer_load_dwordx2 v[214:215], v5, s[60:63], s99 offen offset:1152 nt
    buffer_load_dwordx2 v[216:217], v5, s[60:63], s99 offen offset:2048 nt
    buffer_load_dwordx2 v[218:219], v5, s[60:63], s99 offen offset:2176 nt
    buffer_load_dwordx2 v[220:221], v5, s[60:63], s99 offen offset:3072 nt
    buffer_load_dwordx2 v[222:223], v5, s[60:63], s99 offen offset:3200 nt
    s_lshl_b32 s96, s7, 13
    s_add_u32 s96, s96, 458752
    s_add_u32 s97, s96, 4096
    s_add_u32 s98, s96, 8192
    s_add_u32 s99, s96, 12288
    s_lshl_b32 s90, s7, 15
    s_lshl_b32 s8, s91, 7
    s_add_u32 s90, s90, s8
    s_add_u32 s90, s90, 524288
    s_add_u32 s91, s90, 16384
    s_mov_b64 s[52:53], -1
    s_mov_b64 s[54:55], -1
    s_mov_b64 s[56:57], -1
    s_mov_b64 s[58:59], -1
    s_mov_b64 s[60:61], -1
    s_mov_b64 s[62:63], -1
    s_mov_b64 s[64:65], -1
    s_mov_b64 s[66:67], -1
    s_mov_b64 s[68:69], -1
    s_mov_b64 s[70:71], -1
    s_mov_b64 s[72:73], -1
    s_mov_b64 s[74:75], -1
    s_mov_b64 s[76:77], -1
    s_mov_b64 s[78:79], -1
    s_mov_b64 s[80:81], -1
    s_mov_b64 s[82:83], -1
    s_waitcnt vmcnt(24)
    v_perm_b32 v96, v132, v128, s92
    v_perm_b32 v97, v140, v136, s92
    v_perm_b32 v98, v148, v144, s92
    v_perm_b32 v99, v156, v152, s92
    v_perm_b32 v100, v132, v128, s93
    v_perm_b32 v101, v140, v136, s93
    v_perm_b32 v102, v148, v144, s93
    v_perm_b32 v103, v156, v152, s93
    v_perm_b32 v104, v133, v129, s92
    v_perm_b32 v105, v141, v137, s92
    v_perm_b32 v106, v149, v145, s92
    v_perm_b32 v107, v157, v153, s92
    v_perm_b32 v108, v133, v129, s93
    v_perm_b32 v109, v141, v137, s93
    v_perm_b32 v110, v149, v145, s93
    v_perm_b32 v111, v157, v153, s93
    v_perm_b32 v112, v134, v130, s92
    v_perm_b32 v113, v142, v138, s92
    v_perm_b32 v114, v150, v146, s92
    v_perm_b32 v115, v158, v154, s92
    v_perm_b32 v116, v134, v130, s93
    v_perm_b32 v117, v142, v138, s93
    v_perm_b32 v118, v150, v146, s93
    v_perm_b32 v119, v158, v154, s93
    v_perm_b32 v120, v135, v131, s92
    v_perm_b32 v121, v143, v139, s92
    v_perm_b32 v122, v151, v147, s92
    v_perm_b32 v123, v159, v155, s92
    v_perm_b32 v124, v135, v131, s93
    v_perm_b32 v125, v143, v139, s93
    v_perm_b32 v126, v151, v147, s93
    v_perm_b32 v127, v159, v155, s93
    ds_write_b128 v64, v[96:99] offset:0
    ds_write_b128 v65, v[100:103] offset:256
    ds_write_b128 v66, v[104:107] offset:512
    ds_write_b128 v67, v[108:111] offset:768
    ds_write_b128 v68, v[112:115] offset:1024
    ds_write_b128 v69, v[116:119] offset:1280
    ds_write_b128 v70, v[120:123] offset:1536
    ds_write_b128 v71, v[124:127] offset:1792
    ds_read_b128 v[128:131], v72 offset:0
    ds_read_b128 v[132:135], v73 offset:0
    ds_read_b128 v[136:139], v74 offset:0
    ds_read_b128 v[140:143], v75 offset:0
    ds_read_b128 v[144:147], v76 offset:4096
    ds_read_b128 v[148:151], v77 offset:4096
    ds_read_b128 v[152:155], v78 offset:4096
    ds_read_b128 v[156:159], v79 offset:4096
    s_waitcnt vmcnt(16)
    v_perm_b32 v96, v164, v160, s92
    v_perm_b32 v97, v172, v168, s92
    v_perm_b32 v98, v180, v176, s92
    v_perm_b32 v99, v188, v184, s92
    v_perm_b32 v100, v164, v160, s93
    v_perm_b32 v101, v172, v168, s93
    v_perm_b32 v102, v180, v176, s93
    v_perm_b32 v103, v188, v184, s93
    v_perm_b32 v104, v165, v161, s92
    v_perm_b32 v105, v173, v169, s92
    v_perm_b32 v106, v181, v177, s92
    v_perm_b32 v107, v189, v185, s92
    v_perm_b32 v108, v165, v161, s93
    v_perm_b32 v109, v173, v169, s93
    v_perm_b32 v110, v181, v177, s93
    v_perm_b32 v111, v189, v185, s93
    v_perm_b32 v112, v166, v162, s92
    v_perm_b32 v113, v174, v170, s92
    v_perm_b32 v114, v182, v178, s92
    v_perm_b32 v115, v190, v186, s92
    v_perm_b32 v116, v166, v162, s93
    v_perm_b32 v117, v174, v170, s93
    v_perm_b32 v118, v182, v178, s93
    v_perm_b32 v119, v190, v186, s93
    v_perm_b32 v120, v167, v163, s92
    v_perm_b32 v121, v175, v171, s92
    v_perm_b32 v122, v183, v179, s92
    v_perm_b32 v123, v191, v187, s92
    v_perm_b32 v124, v167, v163, s93
    v_perm_b32 v125, v175, v171, s93
    v_perm_b32 v126, v183, v179, s93
    v_perm_b32 v127, v191, v187, s93
    ds_write_b128 v64, v[96:99] offset:8192
    ds_write_b128 v65, v[100:103] offset:8448
    ds_write_b128 v66, v[104:107] offset:8704
    ds_write_b128 v67, v[108:111] offset:8960
    ds_write_b128 v68, v[112:115] offset:9216
    ds_write_b128 v69, v[116:119] offset:9472
    ds_write_b128 v70, v[120:123] offset:9728
    ds_write_b128 v71, v[124:127] offset:9984
    ds_read_b128 v[160:163], v72 offset:8192
    ds_read_b128 v[164:167], v73 offset:8192
    ds_read_b128 v[168:171], v74 offset:8192
    ds_read_b128 v[172:175], v75 offset:8192
    ds_read_b128 v[176:179], v76 offset:12288
    ds_read_b128 v[180:183], v77 offset:12288
    ds_read_b128 v[184:187], v78 offset:12288
    ds_read_b128 v[188:191], v79 offset:12288
    s_waitcnt vmcnt(0)
    v_perm_b32 v224, v196, v192, s92
    v_perm_b32 v225, v204, v200, s92
    v_perm_b32 v226, v212, v208, s92
    v_perm_b32 v227, v220, v216, s92
    v_perm_b32 v228, v196, v192, s93
    v_perm_b32 v229, v204, v200, s93
    v_perm_b32 v230, v212, v208, s93
    v_perm_b32 v231, v220, v216, s93
    v_perm_b32 v232, v197, v193, s92
    v_perm_b32 v233, v205, v201, s92
    v_perm_b32 v234, v213, v209, s92
    v_perm_b32 v235, v221, v217, s92
    v_perm_b32 v236, v197, v193, s93
    v_perm_b32 v237, v205, v201, s93
    v_perm_b32 v238, v213, v209, s93
    v_perm_b32 v239, v221, v217, s93
    v_perm_b32 v240, v198, v194, s92
    v_perm_b32 v241, v206, v202, s92
    v_perm_b32 v242, v214, v210, s92
    v_perm_b32 v243, v222, v218, s92
    v_perm_b32 v244, v198, v194, s93
    v_perm_b32 v245, v206, v202, s93
    v_perm_b32 v246, v214, v210, s93
    v_perm_b32 v247, v222, v218, s93
    v_perm_b32 v248, v199, v195, s92
    v_perm_b32 v249, v207, v203, s92
    v_perm_b32 v250, v215, v211, s92
    v_perm_b32 v251, v223, v219, s92
    v_perm_b32 v252, v199, v195, s93
    v_perm_b32 v253, v207, v203, s93
    v_perm_b32 v254, v215, v211, s93
    v_perm_b32 v255, v223, v219, s93
    s_mov_b32 s98, 0x00003f80
    s_mov_b32 s99, 0x3f800000
    s_mov_b32 s13, 100000
L_h2p_52:
    s_mov_b64 exec, s[52:53]
    s_cbranch_execz L_ml_53
    buffer_load_dwordx4 v[64:67], v25, s[44:47], s96 offen offset:0 sc1
L_ml_53:
    s_mov_b64 exec, s[54:55]
    s_cbranch_execz L_ml_54
    buffer_load_dwordx4 v[68:71], v25, s[44:47], s96 offen offset:1024 sc1
L_ml_54:
    s_mov_b64 exec, s[56:57]
    s_cbranch_execz L_ml_55
    buffer_load_dwordx4 v[72:75], v25, s[44:47], s96 offen offset:2048 sc1
L_ml_55:
    s_mov_b64 exec, s[58:59]
    s_cbranch_execz L_ml_56
    buffer_load_dwordx4 v[76:79], v25, s[44:47], s96 offen offset:3072 sc1
L_ml_56:
    s_mov_b64 exec, s[60:61]
    s_cbranch_execz L_ml_57
    buffer_load_dwordx4 v[80:83], v25, s[44:47], s97 offen offset:0 sc1
L_ml_57:
    s_mov_b64 exec, s[62:63]
    s_cbranch_execz L_ml_58
    buffer_load_dwordx4 v[84:87], v25, s[44:47], s97 offen offset:1024 sc1
L_ml_58:
    s_mov_b64 exec, s[64:65]
    s_cbranch_execz L_ml_59
    buffer_load_dwordx4 v[88:91], v25, s[44:47], s97 offen offset:2048 sc1
L_ml_59:
    s_mov_b64 exec, s[66:67]
    s_cbranch_execz L_ml_60
    buffer_load_dwordx4 v[92:95], v25, s[44:47], s97 offen offset:3072 sc1
L_ml_60:
    s_mov_b64 exec, -1
    s_waitcnt vmcnt(0)
    v_max3_u32 v210, v64, v65, v66
    v_max_u32 v210, v210, v67
    v_cmp_eq_u32 s[52:53], -1, v210
    v_max3_u32 v211, v68, v69, v70
    v_max_u32 v211, v211, v71
    v_cmp_eq_u32 s[54:55], -1, v211
    v_max3_u32 v210, v72, v73, v74
    v_max_u32 v210, v210, v75
    v_cmp_eq_u32 s[56:57], -1, v210
    v_max3_u32 v211, v76, v77, v78
    v_max_u32 v211, v211, v79
    v_cmp_eq_u32 s[58:59], -1, v211
    v_max3_u32 v210, v80, v81, v82
    v_max_u32 v210, v210, v83
    v_cmp_eq_u32 s[60:61], -1, v210
    v_max3_u32 v211, v84, v85, v86
    v_max_u32 v211, v211, v87
    v_cmp_eq_u32 s[62:63], -1, v211
    v_max3_u32 v210, v88, v89, v90
    v_max_u32 v210, v210, v91
    v_cmp_eq_u32 s[64:65], -1, v210
    v_max3_u32 v211, v92, v93, v94
    v_max_u32 v211, v211, v95
    v_cmp_eq_u32 s[66:67], -1, v211
    s_or_b64 s[100:101], s[52:53], s[54:55]
    s_or_b64 s[100:101], s[100:101], s[56:57]
    s_or_b64 s[100:101], s[100:101], s[58:59]
    s_or_b64 s[100:101], s[100:101], s[60:61]
    s_or_b64 s[100:101], s[100:101], s[62:63]
    s_or_b64 s[100:101], s[100:101], s[64:65]
    s_or_b64 s[100:101], s[100:101], s[66:67]
    s_cbranch_scc0 L_h2p_52_done
    s_sub_u32 s13, s13, 1
    s_cbranch_scc0 L_h2p_52
L_h2p_52_done:
    v_dot2_f32_bf16 v192, v64, s98, 0
    v_dot2_f32_bf16 v193, v64, s99, 0
    v_dot2_f32_bf16 v194, v65, s98, 0
    v_dot2_f32_bf16 v195, v65, s99, 0
    v_dot2_f32_bf16 v196, v66, s98, 0
    v_dot2_f32_bf16 v197, v66, s99, 0
    v_dot2_f32_bf16 v198, v67, s98, 0
    v_dot2_f32_bf16 v199, v67, s99, 0
    v_dot2_f32_bf16 v192, v68, s98, v192
    v_dot2_f32_bf16 v193, v68, s99, v193
    v_dot2_f32_bf16 v194, v69, s98, v194
    v_dot2_f32_bf16 v195, v69, s99, v195
    v_dot2_f32_bf16 v196, v70, s98, v196
    v_dot2_f32_bf16 v197, v70, s99, v197
    v_dot2_f32_bf16 v198, v71, s98, v198
    v_dot2_f32_bf16 v199, v71, s99, v199
    v_dot2_f32_bf16 v192, v72, s98, v192
    v_dot2_f32_bf16 v193, v72, s99, v193
    v_dot2_f32_bf16 v194, v73, s98, v194
    v_dot2_f32_bf16 v195, v73, s99, v195
    v_dot2_f32_bf16 v196, v74, s98, v196
    v_dot2_f32_bf16 v197, v74, s99, v197
    v_dot2_f32_bf16 v198, v75, s98, v198
    v_dot2_f32_bf16 v199, v75, s99, v199
    v_dot2_f32_bf16 v192, v76, s98, v192
    v_dot2_f32_bf16 v193, v76, s99, v193
    v_dot2_f32_bf16 v194, v77, s98, v194
    v_dot2_f32_bf16 v195, v77, s99, v195
    v_dot2_f32_bf16 v196, v78, s98, v196
    v_dot2_f32_bf16 v197, v78, s99, v197
    v_dot2_f32_bf16 v198, v79, s98, v198
    v_dot2_f32_bf16 v199, v79, s99, v199
    v_dot2_f32_bf16 v192, v80, s98, v192
    v_dot2_f32_bf16 v193, v80, s99, v193
    v_dot2_f32_bf16 v194, v81, s98, v194
    v_dot2_f32_bf16 v195, v81, s99, v195
    v_dot2_f32_bf16 v196, v82, s98, v196
    v_dot2_f32_bf16 v197, v82, s99, v197
    v_dot2_f32_bf16 v198, v83, s98, v198
    v_dot2_f32_bf16 v199, v83, s99, v199
    v_dot2_f32_bf16 v192, v84, s98, v192
    v_dot2_f32_bf16 v193, v84, s99, v193
    v_dot2_f32_bf16 v194, v85, s98, v194
    v_dot2_f32_bf16 v195, v85, s99, v195
    v_dot2_f32_bf16 v196, v86, s98, v196
    v_dot2_f32_bf16 v197, v86, s99, v197
    v_dot2_f32_bf16 v198, v87, s98, v198
    v_dot2_f32_bf16 v199, v87, s99, v199
    v_dot2_f32_bf16 v192, v88, s98, v192
    v_dot2_f32_bf16 v193, v88, s99, v193
    v_dot2_f32_bf16 v194, v89, s98, v194
    v_dot2_f32_bf16 v195, v89, s99, v195
    v_dot2_f32_bf16 v196, v90, s98, v196
    v_dot2_f32_bf16 v197, v90, s99, v197
    v_dot2_f32_bf16 v198, v91, s98, v198
    v_dot2_f32_bf16 v199, v91, s99, v199
    v_dot2_f32_bf16 v192, v92, s98, v192
    v_dot2_f32_bf16 v193, v92, s99, v193
    v_dot2_f32_bf16 v194, v93, s98, v194
    v_dot2_f32_bf16 v195, v93, s99, v195
    v_dot2_f32_bf16 v196, v94, s98, v196
    v_dot2_f32_bf16 v197, v94, s99, v197
    v_dot2_f32_bf16 v198, v95, s98, v198
    v_dot2_f32_bf16 v199, v95, s99, v199
    v_fma_f32 v192, v192, v40, v32
    v_fma_f32 v193, v193, v41, v33
    v_fma_f32 v194, v194, v42, v34
    v_fma_f32 v195, v195, v43, v35
    v_fma_f32 v196, v196, v44, v36
    v_fma_f32 v197, v197, v45, v37
    v_fma_f32 v198, v198, v46, v38
    v_fma_f32 v199, v199, v47, v39
    v_readfirstlane_b32 s8, v192
    s_nop 1
    v_subrev_f32 v200, s8, v192
    v_subrev_f32 v201, s8, v193
    v_subrev_f32 v202, s8, v194
    v_subrev_f32 v203, s8, v195
    v_subrev_f32 v204, s8, v196
    v_subrev_f32 v205, s8, v197
    v_subrev_f32 v206, s8, v198
    v_subrev_f32 v207, s8, v199
    v_add_f32 v208, v200, v201
    v_mul_f32 v209, v200, v200
    v_add_f32 v210, v202, v203
    v_mul_f32 v211, v201, v201
    v_add_f32 v212, v204, v205
    v_add_f32 v213, v206, v207
    v_fmac_f32 v209, v202, v202
    v_fmac_f32 v211, v203, v203
    v_fmac_f32 v209, v204, v204
    v_fmac_f32 v211, v205, v205
    v_fmac_f32 v209, v206, v206
    v_fmac_f32 v211, v207, v207
    v_add_f32 v208, v208, v210
    v_add_f32 v212, v212, v213
    v_add_f32 v209, v209, v211
    v_add_f32 v208, v208, v212
    s_nop 1
    v_add_f32_dpp v208, v208, v208 row_ror:8 row_mask:0xf bank_mask:0xf
    v_add_f32_dpp v209, v209, v209 row_ror:8 row_mask:0xf bank_mask:0xf
    s_nop 0
    v_add_f32_dpp v208, v208, v208 row_ror:4 row_mask:0xf bank_mask:0xf
    v_add_f32_dpp v209, v209, v209 row_ror:4 row_mask:0xf bank_mask:0xf
    s_nop 0
    v_add_f32_dpp v208, v208, v208 row_ror:2 row_mask:0xf bank_mask:0xf
    v_add_f32_dpp v209, v209, v209 row_ror:2 row_mask:0xf bank_mask:0xf
    s_nop 0
    v_add_f32_dpp v208, v208, v208 row_ror:1 row_mask:0xf bank_mask:0xf
    v_add_f32_dpp v209, v209, v209 row_ror:1 row_mask:0xf bank_mask:0xf
    v_mov_b32 v210, v208
    v_mov_b32 v211, v209
    s_nop 0
    v_permlane16_swap_b32 v208, v210
    v_permlane16_swap_b32 v209, v211
    v_add_f32 v208, v208, v210
    v_add_f32 v209, v209, v211
    v_mov_b32 v210, v208
    v_mov_b32 v211, v209
    s_nop 0
    v_permlane32_swap_b32 v208, v210
    v_permlane32_swap_b32 v209, v211
    v_add_f32 v208, v208, v210
    v_add_f32 v209, v209, v211
    v_mul_f32 v210, 0x3b000000, v208
    v_fma_f32 v209, -v210, v208, v209
    v_mov_b32 v211, 0x3727c5ac
    v_fmamk_f32 v209, v209, 0x3b000000, v211
    v_rsq_f32 v209, v209
    v_sub_f32 v200, v200, v210
    v_sub_f32 v201, v201, v210
    v_sub_f32 v202, v202, v210
    v_sub_f32 v203, v203, v210
    v_sub_f32 v204, v204, v210
    v_sub_f32 v205, v205, v210
    v_sub_f32 v206, v206, v210
    v_sub_f32 v207, v207, v210
    v_mul_f32 v200, v200, v48
    v_mul_f32 v201, v201, v49
    v_mul_f32 v202, v202, v50
    v_mul_f32 v203, v203, v51
    v_mul_f32 v204, v204, v52
    v_mul_f32 v205, v205, v53
    v_mul_f32 v206, v206, v54
    v_mul_f32 v207, v207, v55
    v_fma_f32 v200, v200, v209, v56
    v_fma_f32 v201, v201, v209, v57
    v_fma_f32 v202, v202, v209, v58
    v_fma_f32 v203, v203, v209, v59
    v_fma_f32 v204, v204, v209, v60
    v_fma_f32 v205, v205, v209, v61
    v_fma_f32 v206, v206, v209, v62
    v_fma_f32 v207, v207, v209, v63
    v_cvt_pk_bf16_f32 v192, v200, v201
    v_cvt_pk_bf16_f32 v193, v202, v203
    v_cvt_pk_bf16_f32 v194, v204, v205
    v_cvt_pk_bf16_f32 v195, v206, v207
    ds_write_b128 v12, v[192:195]
    s_waitcnt lgkmcnt(0)
    s_barrier
    ds_read_b128 v[32:35], v13 offset:0
    ds_read_b128 v[36:39], v13 offset:64
    ds_read_b128 v[40:43], v13 offset:128
    ds_read_b128 v[44:47], v13 offset:192
    s_waitcnt lgkmcnt(3)
    v_mfma_f32_16x16x32_bf16 v[200:203], v[32:35], v[128:131], 0
    v_mfma_f32_16x16x32_bf16 v[204:207], v[32:35], v[144:147], 0
    v_mfma_f32_16x16x32_bf16 v[208:211], v[32:35], v[160:163], 0
    v_mfma_f32_16x16x32_bf16 v[212:215], v[32:35], v[176:179], 0
    s_waitcnt lgkmcnt(2)
    v_mfma_f32_16x16x32_bf16 v[200:203], v[36:39], v[132:135], v[200:203]
    v_mfma_f32_16x16x32_bf16 v[204:207], v[36:39], v[148:151], v[204:207]
    v_mfma_f32_16x16x32_bf16 v[208:211], v[36:39], v[164:167], v[208:211]
    v_mfma_f32_16x16x32_bf16 v[212:215], v[36:39], v[180:183], v[212:215]
    s_waitcnt lgkmcnt(1)
    v_mfma_f32_16x16x32_bf16 v[200:203], v[40:43], v[136:139], v[200:203]
    v_mfma_f32_16x16x32_bf16 v[204:207], v[40:43], v[152:155], v[204:207]
    v_mfma_f32_16x16x32_bf16 v[208:211], v[40:43], v[168:171], v[208:211]
    v_mfma_f32_16x16x32_bf16 v[212:215], v[40:43], v[184:187], v[212:215]
    s_waitcnt lgkmcnt(0)
    v_mfma_f32_16x16x32_bf16 v[200:203], v[44:47], v[140:143], v[200:203]
    v_mfma_f32_16x16x32_bf16 v[204:207], v[44:47], v[156:159], v[204:207]
    v_mfma_f32_16x16x32_bf16 v[208:211], v[44:47], v[172:175], v[208:211]
    v_mfma_f32_16x16x32_bf16 v[212:215], v[44:47], v[188:191], v[212:215]
    s_nop 4
    ds_write_b32 v14, v200 offset:0
    ds_write_b32 v14, v204 offset:64
    ds_write_b32 v14, v208 offset:512
    ds_write_b32 v14, v212 offset:576
    s_waitcnt lgkmcnt(0)
    s_barrier
    ds_read_b128 v[48:51], v15 offset:0
    ds_read_b128 v[52:55], v15 offset:1024
    ds_read_b128 v[56:59], v15 offset:2048
    ds_read_b128 v[60:63], v15 offset:3072
    s_waitcnt lgkmcnt(2)
    v_add_f32 v48, v48, v52
    v_add_f32 v49, v49, v53
    v_add_f32 v50, v50, v54
    v_add_f32 v51, v51, v55
    s_waitcnt lgkmcnt(0)
    v_add_f32 v56, v56, v60
    v_add_f32 v57, v57, v61
    v_add_f32 v58, v58, v62
    v_add_f32 v59, v59, v63
    v_add_f32 v48, v48, v56
    v_add_f32 v49, v49, v57
    v_add_f32 v50, v50, v58
    v_add_f32 v51, v51, v59
    v_cvt_pk_bf16_f32 v52, v48, v49
    v_lshlrev_b32 v48, 16, v52
    v_and_b32 v49, s14, v52
    v_cvt_pk_bf16_f32 v53, v50, v51
    v_lshlrev_b32 v50, 16, v53
    v_and_b32 v51, s14, v53
    s_nop 0
    v_mul_f32_dpp v52, v48, v48 quad_perm:[2,3,0,1] row_mask:0xf bank_mask:0xf
    v_mul_f32_dpp v53, v49, v49 quad_perm:[2,3,0,1] row_mask:0xf bank_mask:0xf
    v_mul_f32_dpp v54, v50, v50 quad_perm:[2,3,0,1] row_mask:0xf bank_mask:0xf
    v_mul_f32_dpp v55, v51, v51 quad_perm:[2,3,0,1] row_mask:0xf bank_mask:0xf
    v_cvt_pk_bf16_f32 v56, v52, v53
    v_cvt_pk_bf16_f32 v57, v54, v55
    s_nop 1
    v_mov_b32_dpp v216, v56 quad_perm:[0,0,0,0] row_mask:0xf bank_mask:0xf
    v_mov_b32_dpp v217, v57 quad_perm:[0,0,0,0] row_mask:0xf bank_mask:0xf
    v_mov_b32_dpp v218, v56 quad_perm:[1,1,1,1] row_mask:0xf bank_mask:0xf
    v_mov_b32_dpp v219, v57 quad_perm:[1,1,1,1] row_mask:0xf bank_mask:0xf
    s_nop 1
    v_mfma_f32_16x16x32_bf16 v[32:35], v[216:219], v[224:227], 0
    v_mfma_f32_16x16x32_bf16 v[36:39], v[216:219], v[228:231], 0
    v_mfma_f32_16x16x32_bf16 v[40:43], v[216:219], v[232:235], 0
    v_mfma_f32_16x16x32_bf16 v[44:47], v[216:219], v[236:239], 0
    v_mfma_f32_16x16x32_bf16 v[48:51], v[216:219], v[240:243], 0
    v_mfma_f32_16x16x32_bf16 v[52:55], v[216:219], v[244:247], 0
    v_mfma_f32_16x16x32_bf16 v[56:59], v[216:219], v[248:251], 0
    v_mfma_f32_16x16x32_bf16 v[60:63], v[216:219], v[252:255], 0
    s_nop 3
    v_mov_b32 v33, v36
    v_mov_b32 v34, v40
    v_mov_b32 v35, v44
    buffer_store_dwordx4 v[32:35], v16, s[44:47], s90 offen sc1
    s_nop 0
    v_mov_b32 v49, v52
    v_mov_b32 v50, v56
    v_mov_b32 v51, v60
    buffer_store_dwordx4 v[48:51], v16, s[44:47], s91 offen sc1
L_exit:
    s_endpgm
.section .rodata,"a"
.p2align 6
.amdhsa_kernel adaLN_cond__gqa_block_cached__glu_gated_bilinear__decode_kernel
  .amdhsa_next_free_vgpr 256
  .amdhsa_next_free_sgpr 102
  .amdhsa_accum_offset 256
  .amdhsa_group_segment_fixed_size 0
  .amdhsa_kernarg_size 112
  .amdhsa_user_sgpr_count 2
  .amdhsa_user_sgpr_kernarg_segment_ptr 1
  .amdhsa_system_sgpr_workgroup_id_x 1
.end_amdhsa_kernel
```
